```python
import torch

def _softmax(x, axis=-1):
    return torch.softmax(x, dim=axis)
def _gelu(x):
    return torch.nn.functional.gelu(x, approximate="tanh")
def _silu(x):
    return torch.nn.functional.silu(x)
def _sigmoid(x):
    return torch.sigmoid(x)
def _layernorm(x, axis=-1, eps=1e-5):
    m = x.mean(dim=axis, keepdim=True)
    v = x.var(dim=axis, keepdim=True, unbiased=False)
    return (x - m) / torch.sqrt(v + eps)
def _scatter_add(tgt, idx, src, axis=0):
    return tgt.clone().index_add_(axis, idx, src)
def _segment_sum(src, seg, n):
    out = torch.zeros((n,) + src.shape[1:], dtype=src.dtype)
    return out.index_add_(0, seg, src)
def _pad(x, pw):
    flat = tuple(v for pair in reversed(pw) for v in pair)
    return torch.nn.functional.pad(x, flat)

kernel_name = 'sequential_preLN__softmax_full_mha__swiglu_ffn__prompt'

def setup_inputs():

    _w = (lambda a: (lambda t: t.to(torch.bfloat16) if t.is_floating_point() else t)(torch.as_tensor(a)))
    def _A_setup():
        B, S, D = 1, 2048, 512
        return {
            "x": _w((lambda *s: torch.randn(*s, dtype=torch.bfloat16) * 0.05)(B, S, D)),
            "wqkv": _w((lambda *s: torch.randn(*s, dtype=torch.bfloat16) * 0.05)(D, 3 * D)),
            "wo": _w((lambda *s: torch.randn(*s, dtype=torch.bfloat16) * 0.05)(D, D)),
        }
    _A_in = _A_setup()

    def _B_setup():
        B, S, D, F = 1, 2048, 512, 1376
        return {
            "x": _w((lambda *s: torch.randn(*s, dtype=torch.bfloat16) * 0.05)(B, S, D)),
            "w_gate": _w((lambda *s: torch.randn(*s, dtype=torch.bfloat16) * 0.05)(D, F)),
            "w_up": _w((lambda *s: torch.randn(*s, dtype=torch.bfloat16) * 0.05)(D, F)),
            "w_down": _w((lambda *s: torch.randn(*s, dtype=torch.bfloat16) * 0.05)(F, D)),
        }
    _B_in = _B_setup()

    return {
        "A_x": _A_in["x"],
        "A_wqkv": _A_in["wqkv"],
        "A_wo": _A_in["wo"],
        "B_x": _B_in["x"],
        "B_w_gate": _B_in["w_gate"],
        "B_w_up": _B_in["w_up"],
        "B_w_down": _B_in["w_down"],
    }

def reference(A_x, A_wqkv, A_wo, B_x, B_w_gate, B_w_up, B_w_down):
    def _A_ref(x, wqkv, wo):
        B, S, D = x.shape
        H = 32; Dh = D // H
        qkv = (lambda x, *d: x.permute(*d))((x @ wqkv).reshape(B, S, 3, H, Dh), 2, 0, 3, 1, 4)
        q, k, v = qkv[0], qkv[1], qkv[2]
        scale = Dh ** -0.5
        scores = torch.einsum("bhqd,bhkd->bhqk", q, k) * scale
        p = _softmax(scores, axis=-1)
        o = torch.einsum("bhqk,bhkd->bhqd", p, v)
        return (lambda x, *d: x.permute(*d))(o, 0, 2, 1, 3).reshape(B, S, D) @ wo

    def _B_ref(x, w_gate, w_up, w_down):
        g = _silu(x @ w_gate)
        u = x @ w_up
        return (g * u) @ w_down

    x = A_x
    h = x + _A_ref(_layernorm(x, axis=-1), A_wqkv, A_wo)
    h2 = h + _B_ref(_layernorm(h, axis=-1), B_w_gate, B_w_up, B_w_down)
    return h2
```

```asm
; @launch grid=(256,1,1) block=(768,1,1) lds=163840
.amdgcn_target "amdgcn-amd-amdhsa--gfx950"
.text
.globl sequential_preLN__softmax_full_mha__swiglu_ffn__prompt_kernel
.p2align 8
.type sequential_preLN__softmax_full_mha__swiglu_ffn__prompt_kernel,@function
sequential_preLN__softmax_full_mha__swiglu_ffn__prompt_kernel:
  s_cmp_ge_u32 s2, 256
  s_cbranch_scc1 L_end
  s_load_dwordx2 s[4:5], s[0:1], 0
  s_load_dwordx2 s[8:9], s[0:1], 8
  s_load_dwordx2 s[28:29], s[0:1], 72
  s_load_dwordx2 s[12:13], s[0:1], 16
  s_load_dwordx4 s[32:35], s[0:1], 32
  s_load_dwordx2 s[20:21], s[0:1], 48
  s_load_dwordx2 s[24:25], s[0:1], 56
  v_lshrrev_b32 v4, 6, v0
  v_and_b32 v1, 63, v0
  v_lshlrev_b32 v2, 4, v1
  v_readfirstlane_b32 s36, v4
  s_and_b32 s37, s2, 7
  s_lshl_b32 s37, s37, 1
  s_lshr_b32 s38, s2, 7
  s_add_u32 s37, s37, s38
  s_lshr_b32 s38, s2, 3
  s_and_b32 s38, s38, 15
  s_mov_b32 s42, 0
  s_mov_b32 s39, 0
  s_mov_b32 s6, 2097152
  s_mov_b32 s7, 0x20000
  s_mov_b32 s10, 1572864
  s_mov_b32 s11, 0x20000
  s_mov_b32 s30, 14422016
  s_mov_b32 s31, 0x20000
  s_mov_b32 s14, 524288
  s_mov_b32 s15, 0x20000
  s_mov_b32 s22, 1409024
  s_mov_b32 s23, 0x20000
  s_mov_b32 s26, 2097152
  s_mov_b32 s27, 0x20000
  s_cmp_lt_u32 s36, 8
  s_cbranch_scc1 L_compute
  s_setprio 3
  s_sub_u32 s78, s36, 8
  v_lshrrev_b32 v4, 3, v1
  v_lshlrev_b32 v4, 10, v4
  v_lshrrev_b32 v5, 4, v1
  v_and_b32 v6, 7, v1
  v_xor_b32 v7, v5, v6
  v_xor_b32 v8, 4, v7
  v_lshl_add_u32 v7, v7, 4, v4
  v_lshl_add_u32 v8, v8, 4, v4
  v_lshrrev_b32 v4, 2, v1
  v_mul_u32_u24 v4, 3072, v4
  v_and_b32 v5, 3, v1
  v_lshl_add_u32 v9, v5, 4, v4
  s_lshl_b32 s58, s38, 17
  s_lshl_b32 s44, s78, 15
  s_add_u32 s58, s58, s44
  s_lshl_b32 s59, s78, 12
  s_lshl_b32 s60, s37, 6
  s_mul_i32 s44, s78, 49152
  s_add_u32 s60, s60, s44
  s_lshl_b32 s61, s78, 10
  s_add_u32 s61, s61, 16384
  s_lshr_b32 s65, s37, 1
  s_and_b32 s44, s37, 1
  s_lshl_b32 s44, s44, 2
  s_add_u32 s65, s65, s44
  s_add_u32 s65, s65, s38
  s_waitcnt lgkmcnt(0)
  s_add_u32 s44, s65, 0
  s_and_b32 s44, s44, 7
  s_lshl_b32 s45, s44, 7
  s_add_u32 s45, s45, s58
  s_mul_i32 s46, s44, 196608
  s_add_u32 s46, s46, s60
  s_mov_b32 m0, s59
  s_nop 0
  buffer_load_dwordx4 v7, s[4:7], s45 offen  lds
  s_add_u32 m0, s59, 1024
  s_add_u32 s53, s45, 8192
  buffer_load_dwordx4 v8, s[4:7], s53 offen  lds
  s_add_u32 m0, s59, 2048
  s_add_u32 s53, s45, 16384
  buffer_load_dwordx4 v7, s[4:7], s53 offen  lds
  s_add_u32 m0, s59, 3072
  s_add_u32 s53, s45, 24576
  buffer_load_dwordx4 v8, s[4:7], s53 offen  lds
  s_mov_b32 m0, s61
  s_nop 0
  buffer_load_dwordx4 v9, s[8:11], s46 offen  lds
  s_add_u32 m0, s61, 4096
  s_add_u32 s53, s46, 1024
  buffer_load_dwordx4 v9, s[8:11], s53 offen  lds
  s_add_u32 m0, s61, 8192
  s_add_u32 s53, s46, 2048
  buffer_load_dwordx4 v9, s[8:11], s53 offen  lds
  buffer_load_dwordx2 v[10:11], off, s[28:31], 0 sc1
  s_add_u32 s44, s65, 1
  s_and_b32 s44, s44, 7
  s_lshl_b32 s45, s44, 7
  s_add_u32 s45, s45, s58
  s_mul_i32 s46, s44, 196608
  s_add_u32 s46, s46, s60
  s_add_u32 m0, s59, 28672
  s_nop 0
  buffer_load_dwordx4 v7, s[4:7], s45 offen  lds
  s_add_u32 m0, s59, 29696
  s_add_u32 s53, s45, 8192
  buffer_load_dwordx4 v8, s[4:7], s53 offen  lds
  s_add_u32 m0, s59, 30720
  s_add_u32 s53, s45, 16384
  buffer_load_dwordx4 v7, s[4:7], s53 offen  lds
  s_add_u32 m0, s59, 31744
  s_add_u32 s53, s45, 24576
  buffer_load_dwordx4 v8, s[4:7], s53 offen  lds
  s_add_u32 m0, s61, 28672
  s_nop 0
  buffer_load_dwordx4 v9, s[8:11], s46 offen  lds
  s_add_u32 m0, s61, 32768
  s_add_u32 s53, s46, 1024
  buffer_load_dwordx4 v9, s[8:11], s53 offen  lds
  s_add_u32 m0, s61, 36864
  s_add_u32 s53, s46, 2048
  buffer_load_dwordx4 v9, s[8:11], s53 offen  lds
  s_mov_b32 s16, s32
  s_mov_b32 s17, s33
  s_mov_b32 s18, 1409024
  s_mov_b32 s19, 0x20000
  s_mov_b32 s92, s34
  s_mov_b32 s93, s35
  s_mov_b32 s94, 1409024
  s_mov_b32 s95, 0x20000
  s_waitcnt vmcnt(8)
  s_barrier
  s_add_u32 s44, s65, 2
  s_and_b32 s44, s44, 7
  s_lshl_b32 s45, s44, 7
  s_add_u32 s45, s45, s58
  s_mul_i32 s46, s44, 196608
  s_add_u32 s46, s46, s60
  s_add_u32 m0, s59, 57344
  s_nop 0
  buffer_load_dwordx4 v7, s[4:7], s45 offen  lds
  s_add_u32 m0, s59, 58368
  s_add_u32 s53, s45, 8192
  buffer_load_dwordx4 v8, s[4:7], s53 offen  lds
  s_add_u32 m0, s59, 59392
  s_add_u32 s53, s45, 16384
  buffer_load_dwordx4 v7, s[4:7], s53 offen  lds
  s_add_u32 m0, s59, 60416
  s_add_u32 s53, s45, 24576
  buffer_load_dwordx4 v8, s[4:7], s53 offen  lds
  s_add_u32 m0, s61, 57344
  s_nop 0
  buffer_load_dwordx4 v9, s[8:11], s46 offen  lds
  s_add_u32 m0, s61, 61440
  s_add_u32 s53, s46, 1024
  buffer_load_dwordx4 v9, s[8:11], s53 offen  lds
  s_add_u32 m0, s61, 65536
  s_add_u32 s53, s46, 2048
  buffer_load_dwordx4 v9, s[8:11], s53 offen  lds
  s_waitcnt vmcnt(7)
  s_barrier
  s_cmp_lg_u32 s36, 8
  s_cbranch_scc1 L_xcc_post_5
  v_readfirstlane_b32 s40, v10
  v_readfirstlane_b32 s41, v11
  s_getreg_b32 s44, hwreg(HW_REG_XCC_ID, 0, 4)
  s_add_u32 s40, s40, 1
  s_addc_u32 s41, s41, 0
  s_lshl_b32 s44, s44, 28
  s_add_u32 s62, s41, s44
  s_lshl_b32 s45, s37, 11
  s_add_u32 s63, s45, 4096
  s_lshl_b32 s45, s38, 7
  s_add_u32 s45, s45, s63
  v_mov_b32 v12, s40
  v_mov_b32 v13, s62
  s_mov_b64 exec, 1
  buffer_store_dwordx2 v[12:13], off, s[28:31], s45 sc1
  s_mov_b64 exec, -1
L_xcc_post_5:
  s_add_u32 s44, s65, 3
  s_and_b32 s44, s44, 7
  s_lshl_b32 s45, s44, 7
  s_add_u32 s45, s45, s58
  s_mul_i32 s46, s44, 196608
  s_add_u32 s46, s46, s60
  s_add_u32 m0, s59, 86016
  s_nop 0
  buffer_load_dwordx4 v7, s[4:7], s45 offen  lds
  s_add_u32 m0, s59, 87040
  s_add_u32 s53, s45, 8192
  buffer_load_dwordx4 v8, s[4:7], s53 offen  lds
  s_add_u32 m0, s59, 88064
  s_add_u32 s53, s45, 16384
  buffer_load_dwordx4 v7, s[4:7], s53 offen  lds
  s_add_u32 m0, s59, 89088
  s_add_u32 s53, s45, 24576
  buffer_load_dwordx4 v8, s[4:7], s53 offen  lds
  s_add_u32 m0, s61, 86016
  s_nop 0
  buffer_load_dwordx4 v9, s[8:11], s46 offen  lds
  s_add_u32 m0, s61, 90112
  s_add_u32 s53, s46, 1024
  buffer_load_dwordx4 v9, s[8:11], s53 offen  lds
  s_add_u32 m0, s61, 94208
  s_add_u32 s53, s46, 2048
  buffer_load_dwordx4 v9, s[8:11], s53 offen  lds
  s_waitcnt vmcnt(7)
  s_barrier
  v_lshrrev_b32 v4, 0, v1
  v_min_u32 v5, 1, v1
  v_add_u32 v4, v4, v5
  v_lshlrev_b32 v4, 15, v4
  s_lshl_b32 s44, s37, 11
  s_lshl_b32 s45, s38, 7
  s_add_u32 s44, s44, s45
  s_add_u32 s44, s44, 36864
  s_mov_b64 exec, 7
  buffer_load_dword v6, v4, s[28:31], s44 offen
  s_mov_b64 exec, -1
  s_add_u32 s44, s65, 4
  s_and_b32 s44, s44, 7
  s_lshl_b32 s45, s44, 7
  s_add_u32 s45, s45, s58
  s_mul_i32 s46, s44, 196608
  s_add_u32 s46, s46, s60
  s_add_u32 m0, s59, 114688
  s_nop 0
  buffer_load_dwordx4 v7, s[4:7], s45 offen  lds
  s_add_u32 m0, s59, 115712
  s_add_u32 s53, s45, 8192
  buffer_load_dwordx4 v8, s[4:7], s53 offen  lds
  s_add_u32 m0, s59, 116736
  s_add_u32 s53, s45, 16384
  buffer_load_dwordx4 v7, s[4:7], s53 offen  lds
  s_add_u32 m0, s59, 117760
  s_add_u32 s53, s45, 24576
  buffer_load_dwordx4 v8, s[4:7], s53 offen  lds
  s_add_u32 m0, s61, 114688
  s_nop 0
  buffer_load_dwordx4 v9, s[8:11], s46 offen  lds
  s_add_u32 m0, s61, 118784
  s_add_u32 s53, s46, 1024
  buffer_load_dwordx4 v9, s[8:11], s53 offen  lds
  s_add_u32 m0, s61, 122880
  s_add_u32 s53, s46, 2048
  buffer_load_dwordx4 v9, s[8:11], s53 offen  lds
  s_waitcnt vmcnt(8)
  s_barrier
  s_add_u32 s44, s65, 5
  s_and_b32 s44, s44, 7
  s_lshl_b32 s45, s44, 7
  s_add_u32 s45, s45, s58
  s_mul_i32 s46, s44, 196608
  s_add_u32 s46, s46, s60
  s_mov_b32 m0, s59
  s_nop 0
  buffer_load_dwordx4 v7, s[4:7], s45 offen  lds
  s_add_u32 m0, s59, 1024
  s_add_u32 s53, s45, 8192
  buffer_load_dwordx4 v8, s[4:7], s53 offen  lds
  s_add_u32 m0, s59, 2048
  s_add_u32 s53, s45, 16384
  buffer_load_dwordx4 v7, s[4:7], s53 offen  lds
  s_add_u32 m0, s59, 3072
  s_add_u32 s53, s45, 24576
  buffer_load_dwordx4 v8, s[4:7], s53 offen  lds
  s_mov_b32 m0, s61
  s_nop 0
  buffer_load_dwordx4 v9, s[8:11], s46 offen  lds
  s_add_u32 m0, s61, 4096
  s_add_u32 s53, s46, 1024
  buffer_load_dwordx4 v9, s[8:11], s53 offen  lds
  s_add_u32 m0, s61, 8192
  s_add_u32 s53, s46, 2048
  buffer_load_dwordx4 v9, s[8:11], s53 offen  lds
  s_waitcnt vmcnt(7)
  s_barrier
  s_add_u32 s44, s65, 6
  s_and_b32 s44, s44, 7
  s_lshl_b32 s45, s44, 7
  s_add_u32 s45, s45, s58
  s_mul_i32 s46, s44, 196608
  s_add_u32 s46, s46, s60
  s_add_u32 m0, s59, 28672
  s_nop 0
  buffer_load_dwordx4 v7, s[4:7], s45 offen  lds
  s_add_u32 m0, s59, 29696
  s_add_u32 s53, s45, 8192
  buffer_load_dwordx4 v8, s[4:7], s53 offen  lds
  s_add_u32 m0, s59, 30720
  s_add_u32 s53, s45, 16384
  buffer_load_dwordx4 v7, s[4:7], s53 offen  lds
  s_add_u32 m0, s59, 31744
  s_add_u32 s53, s45, 24576
  buffer_load_dwordx4 v8, s[4:7], s53 offen  lds
  s_add_u32 m0, s61, 28672
  s_nop 0
  buffer_load_dwordx4 v9, s[8:11], s46 offen  lds
  s_add_u32 m0, s61, 32768
  s_add_u32 s53, s46, 1024
  buffer_load_dwordx4 v9, s[8:11], s53 offen  lds
  s_add_u32 m0, s61, 36864
  s_add_u32 s53, s46, 2048
  buffer_load_dwordx4 v9, s[8:11], s53 offen  lds
  s_waitcnt vmcnt(7)
  s_barrier
  s_lshl_b32 s45, s37, 11
  s_add_u32 s45, s45, 4096
  v_and_b32 v16, 15, v1
  v_lshlrev_b32 v16, 7, v16
  buffer_load_dwordx2 v[14:15], v16, s[28:31], s45 offen sc1
  s_add_u32 s44, s65, 7
  s_and_b32 s44, s44, 7
  s_lshl_b32 s45, s44, 7
  s_add_u32 s45, s45, s58
  s_mul_i32 s46, s44, 196608
  s_add_u32 s46, s46, s60
  s_add_u32 m0, s59, 57344
  s_nop 0
  buffer_load_dwordx4 v7, s[4:7], s45 offen  lds
  s_add_u32 m0, s59, 58368
  s_add_u32 s53, s45, 8192
  buffer_load_dwordx4 v8, s[4:7], s53 offen  lds
  s_add_u32 m0, s59, 59392
  s_add_u32 s53, s45, 16384
  buffer_load_dwordx4 v7, s[4:7], s53 offen  lds
  s_add_u32 m0, s59, 60416
  s_add_u32 s53, s45, 24576
  buffer_load_dwordx4 v8, s[4:7], s53 offen  lds
  s_add_u32 m0, s61, 57344
  s_nop 0
  buffer_load_dwordx4 v9, s[8:11], s46 offen  lds
  s_add_u32 m0, s61, 61440
  s_add_u32 s53, s46, 1024
  buffer_load_dwordx4 v9, s[8:11], s53 offen  lds
  s_add_u32 m0, s61, 65536
  s_add_u32 s53, s46, 2048
  buffer_load_dwordx4 v9, s[8:11], s53 offen  lds
  v_lshlrev_b32 v4, 7, v1
  s_lshl_b32 s44, s37, 1
  s_lshr_b32 s45, s78, 1
  s_add_u32 s44, s44, s45
  s_lshl_b32 s44, s44, 16
  s_lshl_b32 s45, s38, 12
  s_add_u32 s44, s44, s45
  s_and_b32 s45, s78, 1
  s_mul_i32 s45, s45, 2097152
  s_add_u32 s44, s44, s45
  s_add_u32 s44, s44, 262144
  s_mov_b32 exec_hi, 0
  buffer_load_dword v6, v4, s[28:31], s44 offen
  s_mov_b32 exec_hi, -1
  s_waitcnt vmcnt(9)
  s_barrier
  s_waitcnt vmcnt(1)
  s_barrier
  s_cmp_lg_u32 s36, 8
  s_cbranch_scc1 L_fast_decide_6
  v_cmp_ne_u32 vcc, s40, v14
  v_cmp_ne_u32 s[56:57], s62, v15
  s_nop 1
  s_or_b64 vcc, vcc, s[56:57]
  s_cmp_eq_u64 vcc, 0
  s_cselect_b32 s39, 1, 0
  v_mov_b32 v12, s39
  v_mov_b32 v13, 0
  v_mov_b32 v4, 156800
  ds_write_b64 v4, v[12:13]
  s_waitcnt lgkmcnt(0)
L_fast_decide_6:
  s_barrier
  v_lshrrev_b32 v17, 3, v1
  v_lshlrev_b32 v17, 10, v17
  v_bfe_u32 v18, v1, 4, 1
  v_lshlrev_b32 v18, 2, v18
  v_and_b32 v19, 7, v1
  v_xor_b32 v19, v19, v18
  v_lshl_add_u32 v19, v19, 4, v17
  s_mul_i32 s68, s38, 6
  s_lshl_b32 s44, s38, 2
  s_add_u32 s44, s44, 22
  s_min_u32 s68, s68, s44
  s_mul_i32 s66, s78, 44032
  s_lshl_b32 s45, s68, 5
  s_add_u32 s66, s66, s45
  s_mul_i32 s67, s78, 3072
  v_add_u32 v17, 0, v1
  v_mul_u32_u24 v18, 171, v17
  v_lshrrev_b32 v18, 11, v18
  v_mul_u32_u24 v20, 12, v18
  v_sub_u32 v17, v17, v20
  v_mul_u32_u24 v18, 2752, v18
  v_lshl_add_u32 v20, v17, 4, v18
  v_add_u32 v17, 64, v1
  v_mul_u32_u24 v18, 171, v17
  v_lshrrev_b32 v18, 11, v18
  v_mul_u32_u24 v21, 12, v18
  v_sub_u32 v17, v17, v21
  v_mul_u32_u24 v18, 2752, v18
  v_lshl_add_u32 v21, v17, 4, v18
  v_add_u32 v17, 128, v1
  v_mul_u32_u24 v18, 171, v17
  v_lshrrev_b32 v18, 11, v18
  v_mul_u32_u24 v22, 12, v18
  v_sub_u32 v17, v17, v22
  v_mul_u32_u24 v18, 2752, v18
  v_lshl_add_u32 v22, v17, 4, v18
  v_lshlrev_b32 v25, 10, v1
  v_lshrrev_b32 v23, 1, v1
  v_mul_u32_u24 v23, 2752, v23
  v_and_b32 v17, 1, v1
  v_lshl_add_u32 v23, v17, 7, v23
  s_and_b32 s45, s37, 1
  s_cmp_eq_u32 s45, 1
  s_cselect_b32 s96, s34, s32
  s_cselect_b32 s97, s35, s33
  s_mov_b32 s98, 1409024
  s_mov_b32 s99, 0x20000
  s_lshr_b32 s44, s78, 1
  s_lshl_b32 s45, s37, 1
  s_add_u32 s45, s45, s44
  s_lshl_b32 s58, s45, 16
  s_and_b32 s45, s78, 1
  s_mul_i32 s46, s45, 2097152
  s_add_u32 s58, s58, s46
  s_add_u32 s58, s58, 262144
  s_lshl_b32 s59, s78, 12
  s_and_b32 s46, s38, 7
  s_lshl_b32 s77, s46, 1
  s_lshl_b32 s60, s46, 7
  s_lshl_b32 s46, s44, 18
  s_add_u32 s60, s60, s46
  s_lshl_b32 s73, s45, 3
  s_add_u32 s73, s73, s77
  s_lshl_b32 s61, s78, 14
  s_add_u32 s61, s61, 65536
  s_mul_i32 s74, s44, 43
  s_lshl_b32 s46, s45, 1
  s_add_u32 s74, s74, s46
  s_lshl_b32 s74, s74, 14
  s_and_b32 s46, s38, 7
  s_lshl_b32 s46, s46, 7
  s_add_u32 s74, s74, s46
  s_lshl_b32 s75, s78, 12
  s_lshl_b32 s82, s37, 11
  s_lshl_b32 s52, s38, 7
  s_add_u32 s82, s82, s52
  s_add_u32 s82, s82, 36864
  s_lshl_b32 s83, s37, 11
  s_add_u32 s83, s83, 36864
  v_mov_b32 v26, s40
  v_mov_b32 v27, s41
  v_lshlrev_b32 v17, 3, v2
  s_barrier
  s_lshr_b32 s79, s37, 1
  s_cmp_lg_u32 s36, 8
  s_cbranch_scc1 L_attn_others_ld
  s_cmp_lg_u32 s36, 8
  s_cbranch_scc1 L_sync_skip_9
  s_mov_b64 exec, 1
  s_cmp_eq_u32 s39, 0
  s_cbranch_scc1 L_flag_slow_12
  buffer_store_dwordx2 v[26:27], off, s[28:31], s82
  s_branch L_flag_posted_13
L_flag_slow_12:
  buffer_store_dwordx2 v[26:27], off, s[28:31], s82 sc1
L_flag_posted_13:
  s_mov_b64 exec, -1
  s_mov_b64 exec, 0xffff
  s_mov_b32 s46, 0
L_poll_10:
  buffer_load_dwordx2 v[28:29], v17, s[28:31], s83 offen sc1
  s_add_u32 s46, s46, 1
  s_cmp_ge_u32 s46, 131072
  s_waitcnt vmcnt(0)
  s_cbranch_scc1 L_poll_done_11
  v_cmp_ne_u32 vcc, s40, v28
  v_cmp_ne_u32 s[56:57], s41, v29
  s_nop 1
  s_or_b64 vcc, vcc, s[56:57]
  s_cbranch_vccnz L_poll_10
L_poll_done_11:
  s_mov_b64 exec, -1
L_sync_skip_9:
  s_add_u32 s44, s38, 1
  s_and_b32 s44, s44, 15
  s_lshl_b32 s44, s44, 12
  s_add_u32 s44, s44, s58
  s_add_u32 m0, s59, 16384
  s_nop 0
  buffer_load_dwordx4 v2, s[28:31], s44 offen sc1 lds
  buffer_load_dwordx4 v2, s[28:31], s44 offen offset:1024 sc1 lds
  buffer_load_dwordx4 v2, s[28:31], s44 offen offset:2048 sc1 lds
  buffer_load_dwordx4 v2, s[28:31], s44 offen offset:3072 sc1 lds
  s_add_u32 m0, s59, 20480
  s_add_u32 s53, s44, 2097152
  buffer_load_dwordx4 v2, s[28:31], s53 offen sc1 lds
  buffer_load_dwordx4 v2, s[28:31], s53 offen offset:1024 sc1 lds
  buffer_load_dwordx4 v2, s[28:31], s53 offen offset:2048 sc1 lds
  buffer_load_dwordx4 v2, s[28:31], s53 offen offset:3072 sc1 lds
  s_add_u32 m0, s59, 24576
  s_add_u32 s53, s44, 65536
  buffer_load_dwordx4 v2, s[28:31], s53 offen sc1 lds
  buffer_load_dwordx4 v2, s[28:31], s53 offen offset:1024 sc1 lds
  buffer_load_dwordx4 v2, s[28:31], s53 offen offset:2048 sc1 lds
  buffer_load_dwordx4 v2, s[28:31], s53 offen offset:3072 sc1 lds
  s_add_u32 m0, s59, 28672
  s_add_u32 s53, s44, 2162688
  buffer_load_dwordx4 v2, s[28:31], s53 offen sc1 lds
  buffer_load_dwordx4 v2, s[28:31], s53 offen offset:1024 sc1 lds
  buffer_load_dwordx4 v2, s[28:31], s53 offen offset:2048 sc1 lds
  buffer_load_dwordx4 v2, s[28:31], s53 offen offset:3072 sc1 lds
  s_add_u32 s44, s38, 2
  s_and_b32 s44, s44, 15
  s_lshl_b32 s44, s44, 12
  s_add_u32 s44, s44, s58
  s_add_u32 m0, s59, 32768
  s_nop 0
  buffer_load_dwordx4 v2, s[28:31], s44 offen sc1 lds
  buffer_load_dwordx4 v2, s[28:31], s44 offen offset:1024 sc1 lds
  buffer_load_dwordx4 v2, s[28:31], s44 offen offset:2048 sc1 lds
  buffer_load_dwordx4 v2, s[28:31], s44 offen offset:3072 sc1 lds
  s_add_u32 m0, s59, 36864
  s_add_u32 s53, s44, 2097152
  buffer_load_dwordx4 v2, s[28:31], s53 offen sc1 lds
  buffer_load_dwordx4 v2, s[28:31], s53 offen offset:1024 sc1 lds
  buffer_load_dwordx4 v2, s[28:31], s53 offen offset:2048 sc1 lds
  buffer_load_dwordx4 v2, s[28:31], s53 offen offset:3072 sc1 lds
  s_add_u32 m0, s59, 40960
  s_add_u32 s53, s44, 65536
  buffer_load_dwordx4 v2, s[28:31], s53 offen sc1 lds
  buffer_load_dwordx4 v2, s[28:31], s53 offen offset:1024 sc1 lds
  buffer_load_dwordx4 v2, s[28:31], s53 offen offset:2048 sc1 lds
  buffer_load_dwordx4 v2, s[28:31], s53 offen offset:3072 sc1 lds
  s_add_u32 m0, s59, 45056
  s_add_u32 s53, s44, 2162688
  buffer_load_dwordx4 v2, s[28:31], s53 offen sc1 lds
  buffer_load_dwordx4 v2, s[28:31], s53 offen offset:1024 sc1 lds
  buffer_load_dwordx4 v2, s[28:31], s53 offen offset:2048 sc1 lds
  buffer_load_dwordx4 v2, s[28:31], s53 offen offset:3072 sc1 lds
  s_add_u32 s44, s38, 3
  s_and_b32 s44, s44, 15
  s_lshl_b32 s44, s44, 12
  s_add_u32 s44, s44, s58
  s_add_u32 m0, s59, 49152
  s_nop 0
  buffer_load_dwordx4 v2, s[28:31], s44 offen sc1 lds
  buffer_load_dwordx4 v2, s[28:31], s44 offen offset:1024 sc1 lds
  buffer_load_dwordx4 v2, s[28:31], s44 offen offset:2048 sc1 lds
  buffer_load_dwordx4 v2, s[28:31], s44 offen offset:3072 sc1 lds
  s_add_u32 m0, s59, 53248
  s_add_u32 s53, s44, 2097152
  buffer_load_dwordx4 v2, s[28:31], s53 offen sc1 lds
  buffer_load_dwordx4 v2, s[28:31], s53 offen offset:1024 sc1 lds
  buffer_load_dwordx4 v2, s[28:31], s53 offen offset:2048 sc1 lds
  buffer_load_dwordx4 v2, s[28:31], s53 offen offset:3072 sc1 lds
  s_add_u32 m0, s59, 57344
  s_add_u32 s53, s44, 65536
  buffer_load_dwordx4 v2, s[28:31], s53 offen sc1 lds
  buffer_load_dwordx4 v2, s[28:31], s53 offen offset:1024 sc1 lds
  buffer_load_dwordx4 v2, s[28:31], s53 offen offset:2048 sc1 lds
  buffer_load_dwordx4 v2, s[28:31], s53 offen offset:3072 sc1 lds
  s_add_u32 m0, s59, 61440
  s_add_u32 s53, s44, 2162688
  buffer_load_dwordx4 v2, s[28:31], s53 offen sc1 lds
  buffer_load_dwordx4 v2, s[28:31], s53 offen offset:1024 sc1 lds
  buffer_load_dwordx4 v2, s[28:31], s53 offen offset:2048 sc1 lds
  buffer_load_dwordx4 v2, s[28:31], s53 offen offset:3072 sc1 lds
  s_waitcnt vmcnt(32)
  s_barrier
  s_add_u32 s45, s79, 0
  s_and_b32 s45, s45, 7
  s_add_u32 s44, s73, s45
  s_and_b32 s44, s44, 15
  s_lshl_b32 s44, s44, 14
  s_add_u32 s44, s44, s60
  s_lshl_b32 s45, s45, 11
  s_add_u32 s45, s45, s61
  s_mov_b32 m0, s45
  s_nop 0
  buffer_load_dwordx4 v19, s[12:15], s44 offen  lds
  s_add_u32 m0, s45, 1024
  s_add_u32 s53, s44, 8192
  buffer_load_dwordx4 v19, s[12:15], s53 offen  lds
  s_lshl_b32 s44, s79, 2
  s_add_u32 s44, s44, s78
  s_add_u32 s44, s44, 0
  s_and_b32 s44, s44, 31
  s_mul_i32 s44, s44, 44032
  s_lshl_b32 s45, s68, 5
  s_add_u32 s44, s44, s45
  s_mov_b32 exec_hi, 0
  buffer_load_dword v24, v23, s[96:99], s44 offen
  s_mov_b32 exec_hi, -1
  s_waitcnt vmcnt(19)
  s_barrier
  s_add_u32 s44, s38, 4
  s_and_b32 s44, s44, 15
  s_lshl_b32 s44, s44, 12
  s_add_u32 s44, s44, s58
  s_mov_b32 m0, s59
  s_nop 0
  buffer_load_dwordx4 v2, s[28:31], s44 offen sc1 lds
  buffer_load_dwordx4 v2, s[28:31], s44 offen offset:1024 sc1 lds
  buffer_load_dwordx4 v2, s[28:31], s44 offen offset:2048 sc1 lds
  buffer_load_dwordx4 v2, s[28:31], s44 offen offset:3072 sc1 lds
  s_add_u32 s45, s79, 1
  s_and_b32 s45, s45, 7
  s_add_u32 s44, s73, s45
  s_and_b32 s44, s44, 15
  s_lshl_b32 s44, s44, 14
  s_add_u32 s44, s44, s60
  s_lshl_b32 s45, s45, 11
  s_add_u32 s45, s45, s61
  s_mov_b32 m0, s45
  s_nop 0
  buffer_load_dwordx4 v19, s[12:15], s44 offen  lds
  s_add_u32 m0, s45, 1024
  s_add_u32 s53, s44, 8192
  buffer_load_dwordx4 v19, s[12:15], s53 offen  lds
  s_lshl_b32 s44, s79, 2
  s_add_u32 s44, s44, s78
  s_add_u32 s44, s44, 4
  s_and_b32 s44, s44, 31
  s_mul_i32 s44, s44, 44032
  s_lshl_b32 s45, s68, 5
  s_add_u32 s44, s44, s45
  s_mov_b32 exec_hi, 0
  buffer_load_dword v24, v23, s[96:99], s44 offen
  s_mov_b32 exec_hi, -1
  s_waitcnt vmcnt(10)
  s_barrier
  s_add_u32 s44, s38, 5
  s_and_b32 s44, s44, 15
  s_lshl_b32 s44, s44, 12
  s_add_u32 s44, s44, s58
  s_add_u32 m0, s59, 16384
  s_nop 0
  buffer_load_dwordx4 v2, s[28:31], s44 offen sc1 lds
  buffer_load_dwordx4 v2, s[28:31], s44 offen offset:1024 sc1 lds
  buffer_load_dwordx4 v2, s[28:31], s44 offen offset:2048 sc1 lds
  buffer_load_dwordx4 v2, s[28:31], s44 offen offset:3072 sc1 lds
  s_add_u32 s45, s79, 2
  s_and_b32 s45, s45, 7
  s_add_u32 s44, s73, s45
  s_and_b32 s44, s44, 15
  s_lshl_b32 s44, s44, 14
  s_add_u32 s44, s44, s60
  s_lshl_b32 s45, s45, 11
  s_add_u32 s45, s45, s61
  s_mov_b32 m0, s45
  s_nop 0
  buffer_load_dwordx4 v19, s[12:15], s44 offen  lds
  s_add_u32 m0, s45, 1024
  s_add_u32 s53, s44, 8192
  buffer_load_dwordx4 v19, s[12:15], s53 offen  lds
  s_lshl_b32 s44, s79, 2
  s_add_u32 s44, s44, s78
  s_add_u32 s44, s44, 8
  s_and_b32 s44, s44, 31
  s_mul_i32 s44, s44, 44032
  s_lshl_b32 s45, s68, 5
  s_add_u32 s44, s44, s45
  s_mov_b32 exec_hi, 0
  buffer_load_dword v24, v23, s[96:99], s44 offen
  s_mov_b32 exec_hi, -1
  s_branch L_attn_merge_ld
L_attn_others_ld:
  s_barrier
  s_add_u32 s45, s79, 0
  s_and_b32 s45, s45, 7
  s_add_u32 s44, s73, s45
  s_and_b32 s44, s44, 15
  s_lshl_b32 s44, s44, 14
  s_add_u32 s44, s44, s60
  s_lshl_b32 s45, s45, 11
  s_add_u32 s45, s45, s61
  s_mov_b32 m0, s45
  s_nop 0
  buffer_load_dwordx4 v19, s[12:15], s44 offen  lds
  s_add_u32 m0, s45, 1024
  s_add_u32 s53, s44, 8192
  buffer_load_dwordx4 v19, s[12:15], s53 offen  lds
  s_lshl_b32 s44, s79, 2
  s_add_u32 s44, s44, s78
  s_add_u32 s44, s44, 0
  s_and_b32 s44, s44, 31
  s_mul_i32 s44, s44, 44032
  s_lshl_b32 s45, s68, 5
  s_add_u32 s44, s44, s45
  s_mov_b32 exec_hi, 0
  buffer_load_dword v24, v23, s[96:99], s44 offen
  s_mov_b32 exec_hi, -1
  s_barrier
  s_add_u32 s44, s38, 4
  s_and_b32 s44, s44, 15
  s_lshl_b32 s44, s44, 12
  s_add_u32 s44, s44, s58
  s_mov_b32 m0, s59
  s_nop 0
  buffer_load_dwordx4 v2, s[28:31], s44 offen sc1 lds
  buffer_load_dwordx4 v2, s[28:31], s44 offen offset:1024 sc1 lds
  buffer_load_dwordx4 v2, s[28:31], s44 offen offset:2048 sc1 lds
  buffer_load_dwordx4 v2, s[28:31], s44 offen offset:3072 sc1 lds
  s_add_u32 s45, s79, 1
  s_and_b32 s45, s45, 7
  s_add_u32 s44, s73, s45
  s_and_b32 s44, s44, 15
  s_lshl_b32 s44, s44, 14
  s_add_u32 s44, s44, s60
  s_lshl_b32 s45, s45, 11
  s_add_u32 s45, s45, s61
  s_mov_b32 m0, s45
  s_nop 0
  buffer_load_dwordx4 v19, s[12:15], s44 offen  lds
  s_add_u32 m0, s45, 1024
  s_add_u32 s53, s44, 8192
  buffer_load_dwordx4 v19, s[12:15], s53 offen  lds
  s_lshl_b32 s44, s79, 2
  s_add_u32 s44, s44, s78
  s_add_u32 s44, s44, 4
  s_and_b32 s44, s44, 31
  s_mul_i32 s44, s44, 44032
  s_lshl_b32 s45, s68, 5
  s_add_u32 s44, s44, s45
  s_mov_b32 exec_hi, 0
  buffer_load_dword v24, v23, s[96:99], s44 offen
  s_mov_b32 exec_hi, -1
  s_barrier
  s_add_u32 s44, s38, 5
  s_and_b32 s44, s44, 15
  s_lshl_b32 s44, s44, 12
  s_add_u32 s44, s44, s58
  s_add_u32 m0, s59, 16384
  s_nop 0
  buffer_load_dwordx4 v2, s[28:31], s44 offen sc1 lds
  buffer_load_dwordx4 v2, s[28:31], s44 offen offset:1024 sc1 lds
  buffer_load_dwordx4 v2, s[28:31], s44 offen offset:2048 sc1 lds
  buffer_load_dwordx4 v2, s[28:31], s44 offen offset:3072 sc1 lds
  s_add_u32 s45, s79, 2
  s_and_b32 s45, s45, 7
  s_add_u32 s44, s73, s45
  s_and_b32 s44, s44, 15
  s_lshl_b32 s44, s44, 14
  s_add_u32 s44, s44, s60
  s_lshl_b32 s45, s45, 11
  s_add_u32 s45, s45, s61
  s_mov_b32 m0, s45
  s_nop 0
  buffer_load_dwordx4 v19, s[12:15], s44 offen  lds
  s_add_u32 m0, s45, 1024
  s_add_u32 s53, s44, 8192
  buffer_load_dwordx4 v19, s[12:15], s53 offen  lds
  s_lshl_b32 s44, s79, 2
  s_add_u32 s44, s44, s78
  s_add_u32 s44, s44, 8
  s_and_b32 s44, s44, 31
  s_mul_i32 s44, s44, 44032
  s_lshl_b32 s45, s68, 5
  s_add_u32 s44, s44, s45
  s_mov_b32 exec_hi, 0
  buffer_load_dword v24, v23, s[96:99], s44 offen
  s_mov_b32 exec_hi, -1
L_attn_merge_ld:
  s_waitcnt vmcnt(10)
  s_barrier
  s_add_u32 s44, s38, 6
  s_and_b32 s44, s44, 15
  s_lshl_b32 s44, s44, 12
  s_add_u32 s44, s44, s58
  s_add_u32 m0, s59, 32768
  s_nop 0
  buffer_load_dwordx4 v2, s[28:31], s44 offen sc1 lds
  buffer_load_dwordx4 v2, s[28:31], s44 offen offset:1024 sc1 lds
  buffer_load_dwordx4 v2, s[28:31], s44 offen offset:2048 sc1 lds
  buffer_load_dwordx4 v2, s[28:31], s44 offen offset:3072 sc1 lds
  s_add_u32 s45, s79, 3
  s_and_b32 s45, s45, 7
  s_add_u32 s44, s73, s45
  s_and_b32 s44, s44, 15
  s_lshl_b32 s44, s44, 14
  s_add_u32 s44, s44, s60
  s_lshl_b32 s45, s45, 11
  s_add_u32 s45, s45, s61
  s_mov_b32 m0, s45
  s_nop 0
  buffer_load_dwordx4 v19, s[12:15], s44 offen  lds
  s_add_u32 m0, s45, 1024
  s_add_u32 s53, s44, 8192
  buffer_load_dwordx4 v19, s[12:15], s53 offen  lds
  s_lshl_b32 s44, s79, 2
  s_add_u32 s44, s44, s78
  s_add_u32 s44, s44, 12
  s_and_b32 s44, s44, 31
  s_mul_i32 s44, s44, 44032
  s_lshl_b32 s45, s68, 5
  s_add_u32 s44, s44, s45
  s_mov_b32 exec_hi, 0
  buffer_load_dword v24, v23, s[96:99], s44 offen
  s_mov_b32 exec_hi, -1
  s_waitcnt vmcnt(10)
  s_barrier
  s_add_u32 s44, s38, 7
  s_and_b32 s44, s44, 15
  s_lshl_b32 s44, s44, 12
  s_add_u32 s44, s44, s58
  s_add_u32 m0, s59, 49152
  s_nop 0
  buffer_load_dwordx4 v2, s[28:31], s44 offen sc1 lds
  buffer_load_dwordx4 v2, s[28:31], s44 offen offset:1024 sc1 lds
  buffer_load_dwordx4 v2, s[28:31], s44 offen offset:2048 sc1 lds
  buffer_load_dwordx4 v2, s[28:31], s44 offen offset:3072 sc1 lds
  s_add_u32 s45, s79, 4
  s_and_b32 s45, s45, 7
  s_add_u32 s44, s73, s45
  s_and_b32 s44, s44, 15
  s_lshl_b32 s44, s44, 14
  s_add_u32 s44, s44, s60
  s_lshl_b32 s45, s45, 11
  s_add_u32 s45, s45, s61
  s_mov_b32 m0, s45
  s_nop 0
  buffer_load_dwordx4 v19, s[12:15], s44 offen  lds
  s_add_u32 m0, s45, 1024
  s_add_u32 s53, s44, 8192
  buffer_load_dwordx4 v19, s[12:15], s53 offen  lds
  s_lshl_b32 s44, s79, 2
  s_add_u32 s44, s44, s78
  s_add_u32 s44, s44, 16
  s_and_b32 s44, s44, 31
  s_mul_i32 s44, s44, 44032
  s_lshl_b32 s45, s68, 5
  s_add_u32 s44, s44, s45
  s_mov_b32 exec_hi, 0
  buffer_load_dword v24, v23, s[96:99], s44 offen
  s_mov_b32 exec_hi, -1
  s_waitcnt vmcnt(10)
  s_barrier
  s_add_u32 s44, s38, 8
  s_and_b32 s44, s44, 15
  s_lshl_b32 s44, s44, 12
  s_add_u32 s44, s44, s58
  s_mov_b32 m0, s59
  s_nop 0
  buffer_load_dwordx4 v2, s[28:31], s44 offen sc1 lds
  buffer_load_dwordx4 v2, s[28:31], s44 offen offset:1024 sc1 lds
  buffer_load_dwordx4 v2, s[28:31], s44 offen offset:2048 sc1 lds
  buffer_load_dwordx4 v2, s[28:31], s44 offen offset:3072 sc1 lds
  s_add_u32 s45, s79, 5
  s_and_b32 s45, s45, 7
  s_add_u32 s44, s73, s45
  s_and_b32 s44, s44, 15
  s_lshl_b32 s44, s44, 14
  s_add_u32 s44, s44, s60
  s_lshl_b32 s45, s45, 11
  s_add_u32 s45, s45, s61
  s_mov_b32 m0, s45
  s_nop 0
  buffer_load_dwordx4 v19, s[12:15], s44 offen  lds
  s_add_u32 m0, s45, 1024
  s_add_u32 s53, s44, 8192
  buffer_load_dwordx4 v19, s[12:15], s53 offen  lds
  s_lshl_b32 s44, s79, 2
  s_add_u32 s44, s44, s78
  s_add_u32 s44, s44, 20
  s_and_b32 s44, s44, 31
  s_mul_i32 s44, s44, 44032
  s_lshl_b32 s45, s68, 5
  s_add_u32 s44, s44, s45
  s_mov_b32 exec_hi, 0
  buffer_load_dword v24, v23, s[96:99], s44 offen
  s_mov_b32 exec_hi, -1
  s_waitcnt vmcnt(10)
  s_barrier
  s_add_u32 s44, s38, 9
  s_and_b32 s44, s44, 15
  s_lshl_b32 s44, s44, 12
  s_add_u32 s44, s44, s58
  s_add_u32 m0, s59, 16384
  s_nop 0
  buffer_load_dwordx4 v2, s[28:31], s44 offen sc1 lds
  buffer_load_dwordx4 v2, s[28:31], s44 offen offset:1024 sc1 lds
  buffer_load_dwordx4 v2, s[28:31], s44 offen offset:2048 sc1 lds
  buffer_load_dwordx4 v2, s[28:31], s44 offen offset:3072 sc1 lds
  s_add_u32 s45, s79, 6
  s_and_b32 s45, s45, 7
  s_add_u32 s44, s73, s45
  s_and_b32 s44, s44, 15
  s_lshl_b32 s44, s44, 14
  s_add_u32 s44, s44, s60
  s_lshl_b32 s45, s45, 11
  s_add_u32 s45, s45, s61
  s_mov_b32 m0, s45
  s_nop 0
  buffer_load_dwordx4 v19, s[12:15], s44 offen  lds
  s_add_u32 m0, s45, 1024
  s_add_u32 s53, s44, 8192
  buffer_load_dwordx4 v19, s[12:15], s53 offen  lds
  s_lshl_b32 s44, s79, 2
  s_add_u32 s44, s44, s78
  s_add_u32 s44, s44, 24
  s_and_b32 s44, s44, 31
  s_mul_i32 s44, s44, 44032
  s_lshl_b32 s45, s68, 5
  s_add_u32 s44, s44, s45
  s_mov_b32 exec_hi, 0
  buffer_load_dword v24, v23, s[96:99], s44 offen
  s_mov_b32 exec_hi, -1
  s_waitcnt vmcnt(10)
  s_barrier
  s_add_u32 s44, s38, 10
  s_and_b32 s44, s44, 15
  s_lshl_b32 s44, s44, 12
  s_add_u32 s44, s44, s58
  s_add_u32 m0, s59, 32768
  s_nop 0
  buffer_load_dwordx4 v2, s[28:31], s44 offen sc1 lds
  buffer_load_dwordx4 v2, s[28:31], s44 offen offset:1024 sc1 lds
  buffer_load_dwordx4 v2, s[28:31], s44 offen offset:2048 sc1 lds
  buffer_load_dwordx4 v2, s[28:31], s44 offen offset:3072 sc1 lds
  s_add_u32 s45, s79, 7
  s_and_b32 s45, s45, 7
  s_add_u32 s44, s73, s45
  s_and_b32 s44, s44, 15
  s_lshl_b32 s44, s44, 14
  s_add_u32 s44, s44, s60
  s_lshl_b32 s45, s45, 11
  s_add_u32 s45, s45, s61
  s_mov_b32 m0, s45
  s_nop 0
  buffer_load_dwordx4 v19, s[12:15], s44 offen  lds
  s_add_u32 m0, s45, 1024
  s_add_u32 s53, s44, 8192
  buffer_load_dwordx4 v19, s[12:15], s53 offen  lds
  s_lshl_b32 s44, s79, 2
  s_add_u32 s44, s44, s78
  s_add_u32 s44, s44, 28
  s_and_b32 s44, s44, 31
  s_mul_i32 s44, s44, 44032
  s_lshl_b32 s45, s68, 5
  s_add_u32 s44, s44, s45
  s_mov_b32 exec_hi, 0
  buffer_load_dword v24, v23, s[96:99], s44 offen
  s_mov_b32 exec_hi, -1
  s_waitcnt vmcnt(10)
  s_barrier
  s_add_u32 s44, s38, 11
  s_and_b32 s44, s44, 15
  s_lshl_b32 s44, s44, 12
  s_add_u32 s44, s44, s58
  s_add_u32 m0, s59, 49152
  s_nop 0
  buffer_load_dwordx4 v2, s[28:31], s44 offen sc1 lds
  buffer_load_dwordx4 v2, s[28:31], s44 offen offset:1024 sc1 lds
  buffer_load_dwordx4 v2, s[28:31], s44 offen offset:2048 sc1 lds
  buffer_load_dwordx4 v2, s[28:31], s44 offen offset:3072 sc1 lds
  s_add_u32 m0, s67, 131072
  s_nop 0
  buffer_load_dwordx4 v20, s[16:19], s66 offen  lds
  s_add_u32 m0, s67, 132096
  s_nop 0
  buffer_load_dwordx4 v21, s[16:19], s66 offen  lds
  s_add_u32 m0, s67, 133120
  s_nop 0
  buffer_load_dwordx4 v22, s[16:19], s66 offen  lds
  s_waitcnt vmcnt(10)
  s_barrier
  s_add_u32 s44, s38, 12
  s_and_b32 s44, s44, 15
  s_lshl_b32 s44, s44, 12
  s_add_u32 s44, s44, s58
  s_mov_b32 m0, s59
  s_nop 0
  buffer_load_dwordx4 v2, s[28:31], s44 offen sc1 lds
  buffer_load_dwordx4 v2, s[28:31], s44 offen offset:1024 sc1 lds
  buffer_load_dwordx4 v2, s[28:31], s44 offen offset:2048 sc1 lds
  buffer_load_dwordx4 v2, s[28:31], s44 offen offset:3072 sc1 lds
  s_add_u32 m0, s67, 143392
  s_nop 0
  buffer_load_dwordx4 v20, s[92:95], s66 offen  lds
  s_add_u32 m0, s67, 144416
  s_nop 0
  buffer_load_dwordx4 v21, s[92:95], s66 offen  lds
  s_add_u32 m0, s67, 145440
  s_nop 0
  buffer_load_dwordx4 v22, s[92:95], s66 offen  lds
  s_waitcnt vmcnt(10)
  s_barrier
  s_add_u32 s44, s38, 13
  s_and_b32 s44, s44, 15
  s_lshl_b32 s44, s44, 12
  s_add_u32 s44, s44, s58
  s_add_u32 m0, s59, 16384
  s_nop 0
  buffer_load_dwordx4 v2, s[28:31], s44 offen sc1 lds
  buffer_load_dwordx4 v2, s[28:31], s44 offen offset:1024 sc1 lds
  buffer_load_dwordx4 v2, s[28:31], s44 offen offset:2048 sc1 lds
  buffer_load_dwordx4 v2, s[28:31], s44 offen offset:3072 sc1 lds
  v_lshlrev_b32 v4, 3, v2
  s_lshl_b32 s44, s37, 2
  s_add_u32 s44, s44, s78
  s_mul_i32 s44, s44, 86
  s_add_u32 s44, s44, s68
  s_lshl_b32 s44, s44, 10
  s_add_u32 s44, s44, 8650752
  s_cmp_lt_u32 s38, 11
  s_cselect_b32 s45, 0xffff, 0
  s_mov_b32 exec_lo, -1
  s_mov_b32 exec_hi, s45
  buffer_load_dword v24, v4, s[28:31], s44 offen
  s_mov_b64 exec, -1
  s_waitcnt vmcnt(8)
  s_barrier
  s_add_u32 s44, s38, 14
  s_and_b32 s44, s44, 15
  s_lshl_b32 s44, s44, 12
  s_add_u32 s44, s44, s58
  s_add_u32 m0, s59, 32768
  s_nop 0
  buffer_load_dwordx4 v2, s[28:31], s44 offen sc1 lds
  buffer_load_dwordx4 v2, s[28:31], s44 offen offset:1024 sc1 lds
  buffer_load_dwordx4 v2, s[28:31], s44 offen offset:2048 sc1 lds
  buffer_load_dwordx4 v2, s[28:31], s44 offen offset:3072 sc1 lds
  v_lshlrev_b32 v4, 3, v2
  s_lshl_b32 s44, s37, 2
  s_lshr_b32 s45, s38, 3
  s_lshl_b32 s45, s45, 1
  s_add_u32 s44, s44, s45
  s_and_b32 s45, s78, 1
  s_add_u32 s44, s44, s45
  s_and_b32 s45, s38, 7
  s_lshl_b32 s46, s44, 15
  s_lshl_b32 s47, s45, 12
  s_add_u32 s46, s46, s47
  s_add_u32 s46, s46, 6553600
  s_lshl_b32 s44, s44, 3
  s_add_u32 s44, s44, s45
  s_lshl_b32 s44, s44, 8
  s_add_u32 s44, s44, 14290944
  s_cmp_ge_u32 s78, 2
  s_cselect_b32 s44, s44, s46
  s_cselect_b32 s45, 3, -1
  s_mov_b32 exec_lo, s45
  s_mov_b32 exec_hi, 0
  buffer_load_dword v24, v4, s[28:31], s44 offen
  s_mov_b64 exec, -1
  s_waitcnt vmcnt(6)
  s_barrier
  s_add_u32 s44, s38, 15
  s_and_b32 s44, s44, 15
  s_lshl_b32 s44, s44, 12
  s_add_u32 s44, s44, s58
  s_add_u32 m0, s59, 49152
  s_nop 0
  buffer_load_dwordx4 v2, s[28:31], s44 offen sc1 lds
  buffer_load_dwordx4 v2, s[28:31], s44 offen offset:1024 sc1 lds
  buffer_load_dwordx4 v2, s[28:31], s44 offen offset:2048 sc1 lds
  buffer_load_dwordx4 v2, s[28:31], s44 offen offset:3072 sc1 lds
  s_lshl_b32 s44, s37, 1
  s_lshr_b32 s45, s38, 3
  s_add_u32 s44, s44, s45
  s_mul_i32 s44, s44, 43
  s_mul_i32 s45, s78, 11
  s_add_u32 s44, s44, s45
  s_lshl_b32 s44, s44, 10
  s_and_b32 s45, s38, 7
  s_lshl_b32 s45, s45, 7
  s_add_u32 s44, s44, s45
  s_mov_b64 exec, 0x7ff
  buffer_load_dword v24, v25, s[20:23], s44 offen
  s_mov_b64 exec, -1
  s_waitcnt vmcnt(6)
  s_barrier
  s_lshl_b32 s44, s37, 1
  s_lshr_b32 s45, s38, 3
  s_add_u32 s44, s44, s45
  s_lshl_b32 s44, s44, 2
  s_add_u32 s44, s44, s78
  s_lshl_b32 s44, s44, 14
  s_and_b32 s45, s38, 7
  s_lshl_b32 s45, s45, 7
  s_add_u32 s44, s44, s45
  s_mov_b64 exec, 0xffff
  buffer_load_dword v24, v25, s[24:27], s44 offen
  s_mov_b64 exec, -1
  s_lshl_b32 s44, s37, 2
  s_lshr_b32 s45, s38, 3
  s_lshl_b32 s45, s45, 1
  s_add_u32 s44, s44, s45
  s_and_b32 s45, s78, 1
  s_add_u32 s44, s44, s45
  s_lshl_b32 s80, s44, 15
  s_lshl_b32 s81, s45, 15
  s_lshr_b32 s45, s78, 1
  s_lshl_b32 s45, s45, 14
  s_add_u32 s81, s81, s45
  s_add_u32 s80, s80, s45
  s_add_u32 s80, s80, 4456448
  s_lshl_b32 s82, s38, 11
  s_lshl_b32 s52, s37, 7
  s_add_u32 s82, s82, s52
  s_add_u32 s82, s82, 69632
  s_lshl_b32 s83, s37, 11
  s_add_u32 s83, s83, 69632
  v_mov_b32 v4, s40
  v_mov_b32 v5, s41
  v_lshlrev_b32 v8, 3, v2
  s_waitcnt vmcnt(2)
  s_barrier
  s_barrier
  s_waitcnt vmcnt(0)
  s_barrier
  v_mov_b32 v9, 156804
  ds_read_b32 v10, v9
  s_waitcnt lgkmcnt(0)
  v_readfirstlane_b32 s44, v10
  s_nop 1
  s_cmp_eq_u32 s44, 0
  s_cbranch_scc1 L_attn_ok_ld
  s_cmp_lg_u32 s42, 0
  s_cbranch_scc1 L_attn_ok_ld
  s_mov_b32 s42, 1
  s_add_u32 s44, s38, 0
  s_and_b32 s44, s44, 15
  s_lshl_b32 s44, s44, 12
  s_add_u32 s44, s44, s58
  s_mov_b32 m0, s59
  s_nop 0
  buffer_load_dwordx4 v2, s[28:31], s44 offen sc1 lds
  buffer_load_dwordx4 v2, s[28:31], s44 offen offset:1024 sc1 lds
  buffer_load_dwordx4 v2, s[28:31], s44 offen offset:2048 sc1 lds
  buffer_load_dwordx4 v2, s[28:31], s44 offen offset:3072 sc1 lds
  s_add_u32 s44, s38, 1
  s_and_b32 s44, s44, 15
  s_lshl_b32 s44, s44, 12
  s_add_u32 s44, s44, s58
  s_add_u32 m0, s59, 16384
  s_nop 0
  buffer_load_dwordx4 v2, s[28:31], s44 offen sc1 lds
  buffer_load_dwordx4 v2, s[28:31], s44 offen offset:1024 sc1 lds
  buffer_load_dwordx4 v2, s[28:31], s44 offen offset:2048 sc1 lds
  buffer_load_dwordx4 v2, s[28:31], s44 offen offset:3072 sc1 lds
  s_add_u32 s44, s38, 2
  s_and_b32 s44, s44, 15
  s_lshl_b32 s44, s44, 12
  s_add_u32 s44, s44, s58
  s_add_u32 m0, s59, 32768
  s_nop 0
  buffer_load_dwordx4 v2, s[28:31], s44 offen sc1 lds
  buffer_load_dwordx4 v2, s[28:31], s44 offen offset:1024 sc1 lds
  buffer_load_dwordx4 v2, s[28:31], s44 offen offset:2048 sc1 lds
  buffer_load_dwordx4 v2, s[28:31], s44 offen offset:3072 sc1 lds
  s_add_u32 s44, s38, 3
  s_and_b32 s44, s44, 15
  s_lshl_b32 s44, s44, 12
  s_add_u32 s44, s44, s58
  s_add_u32 m0, s59, 49152
  s_nop 0
  buffer_load_dwordx4 v2, s[28:31], s44 offen sc1 lds
  buffer_load_dwordx4 v2, s[28:31], s44 offen offset:1024 sc1 lds
  buffer_load_dwordx4 v2, s[28:31], s44 offen offset:2048 sc1 lds
  buffer_load_dwordx4 v2, s[28:31], s44 offen offset:3072 sc1 lds
  s_waitcnt vmcnt(0)
  s_barrier
  s_branch L_attn_others_ld
L_attn_ok_ld:
  s_cmp_lg_u32 s36, 8
  s_cbranch_scc1 L_sync_skip_19
  s_mov_b64 exec, 1
  buffer_store_dwordx2 v[4:5], off, s[28:31], s82 sc1
  s_mov_b64 exec, -1
  s_mov_b64 exec, 0xffff
  s_mov_b32 s46, 0
L_poll_20:
  buffer_load_dwordx2 v[6:7], v8, s[28:31], s83 offen sc1
  s_add_u32 s46, s46, 1
  s_cmp_ge_u32 s46, 131072
  s_waitcnt vmcnt(0)
  s_cbranch_scc1 L_poll_done_21
  v_cmp_ne_u32 vcc, s40, v6
  v_cmp_ne_u32 s[56:57], s41, v7
  s_nop 1
  s_or_b64 vcc, vcc, s[56:57]
  s_cbranch_vccnz L_poll_20
L_poll_done_21:
  s_cmp_lg_u32 s2, 0
  s_cbranch_scc1 L_zupd_22
  s_mov_b64 exec, 1
  buffer_store_dwordx2 v[4:5], off, s[28:31], 0 sc1
L_zupd_22:
  s_mov_b64 exec, -1
L_sync_skip_19:
  s_barrier
  s_add_u32 s44, s77, 0
  s_and_b32 s44, s44, 15
  s_lshl_b32 s44, s44, 10
  s_add_u32 s44, s44, s80
  s_mov_b32 m0, s81
  s_nop 0
  buffer_load_dwordx4 v2, s[28:31], s44 offen sc1 lds
  buffer_load_dwordx4 v2, s[28:31], s44 offen offset:1024 sc1 lds
  s_add_u32 s44, s77, 2
  s_and_b32 s44, s44, 15
  s_lshl_b32 s44, s44, 10
  s_add_u32 s44, s44, s80
  s_add_u32 m0, s81, 2048
  s_nop 0
  buffer_load_dwordx4 v2, s[28:31], s44 offen sc1 lds
  buffer_load_dwordx4 v2, s[28:31], s44 offen offset:1024 sc1 lds
  s_add_u32 s44, s77, 4
  s_and_b32 s44, s44, 15
  s_lshl_b32 s44, s44, 10
  s_add_u32 s44, s44, s80
  s_add_u32 m0, s81, 4096
  s_nop 0
  buffer_load_dwordx4 v2, s[28:31], s44 offen sc1 lds
  buffer_load_dwordx4 v2, s[28:31], s44 offen offset:1024 sc1 lds
  s_add_u32 s44, s77, 6
  s_and_b32 s44, s44, 15
  s_lshl_b32 s44, s44, 10
  s_add_u32 s44, s44, s80
  s_add_u32 m0, s81, 6144
  s_nop 0
  buffer_load_dwordx4 v2, s[28:31], s44 offen sc1 lds
  buffer_load_dwordx4 v2, s[28:31], s44 offen offset:1024 sc1 lds
  s_waitcnt vmcnt(4)
  s_barrier
  s_add_u32 s44, s77, 8
  s_and_b32 s44, s44, 15
  s_lshl_b32 s44, s44, 10
  s_add_u32 s44, s44, s80
  s_add_u32 m0, s81, 8192
  s_nop 0
  buffer_load_dwordx4 v2, s[28:31], s44 offen sc1 lds
  buffer_load_dwordx4 v2, s[28:31], s44 offen offset:1024 sc1 lds
  s_add_u32 s44, s77, 10
  s_and_b32 s44, s44, 15
  s_lshl_b32 s44, s44, 10
  s_add_u32 s44, s44, s80
  s_add_u32 m0, s81, 10240
  s_nop 0
  buffer_load_dwordx4 v2, s[28:31], s44 offen sc1 lds
  buffer_load_dwordx4 v2, s[28:31], s44 offen offset:1024 sc1 lds
  s_waitcnt vmcnt(4)
  s_barrier
  s_add_u32 s44, s77, 12
  s_and_b32 s44, s44, 15
  s_lshl_b32 s44, s44, 10
  s_add_u32 s44, s44, s80
  s_add_u32 m0, s81, 12288
  s_nop 0
  buffer_load_dwordx4 v2, s[28:31], s44 offen sc1 lds
  buffer_load_dwordx4 v2, s[28:31], s44 offen offset:1024 sc1 lds
  s_add_u32 s44, s77, 14
  s_and_b32 s44, s44, 15
  s_lshl_b32 s44, s44, 10
  s_add_u32 s44, s44, s80
  s_add_u32 m0, s81, 14336
  s_nop 0
  buffer_load_dwordx4 v2, s[28:31], s44 offen sc1 lds
  buffer_load_dwordx4 v2, s[28:31], s44 offen offset:1024 sc1 lds
  s_waitcnt vmcnt(4)
  s_barrier
  s_waitcnt vmcnt(0)
  s_barrier
  s_barrier
  s_mov_b32 m0, s67
  s_add_u32 s53, s66, 176128
  buffer_load_dwordx4 v20, s[16:19], s53 offen  lds
  s_add_u32 m0, s67, 1024
  s_add_u32 s53, s66, 176128
  buffer_load_dwordx4 v21, s[16:19], s53 offen  lds
  s_add_u32 m0, s67, 2048
  s_add_u32 s53, s66, 176128
  buffer_load_dwordx4 v22, s[16:19], s53 offen  lds
  s_add_u32 m0, s67, 12320
  s_add_u32 s53, s66, 176128
  buffer_load_dwordx4 v20, s[92:95], s53 offen  lds
  s_add_u32 m0, s67, 13344
  s_add_u32 s53, s66, 176128
  buffer_load_dwordx4 v21, s[92:95], s53 offen  lds
  s_add_u32 m0, s67, 14368
  s_add_u32 s53, s66, 176128
  buffer_load_dwordx4 v22, s[92:95], s53 offen  lds
  s_lshl_b32 s44, s37, 2
  s_add_u32 s44, s44, s78
  s_lshl_b32 s84, s44, 15
  s_add_u32 s84, s84, 6553600
  s_lshl_b32 s85, s78, 12
  s_lshl_b32 s82, s37, 11
  s_lshl_b32 s52, s38, 7
  s_add_u32 s82, s82, s52
  s_add_u32 s82, s82, 102400
  s_lshl_b32 s83, s37, 11
  s_add_u32 s83, s83, 102400
  v_mov_b32 v4, s40
  v_mov_b32 v5, s41
  v_lshlrev_b32 v8, 3, v2
  s_barrier
  s_barrier
  s_cmp_lg_u32 s36, 8
  s_cbranch_scc1 L_sync_skip_23
  s_mov_b64 exec, 1
  s_cmp_eq_u32 s39, 0
  s_cbranch_scc1 L_flag_slow_26
  buffer_store_dwordx2 v[4:5], off, s[28:31], s82
  s_branch L_flag_posted_27
L_flag_slow_26:
  buffer_store_dwordx2 v[4:5], off, s[28:31], s82 sc1
L_flag_posted_27:
  s_mov_b64 exec, -1
  s_mov_b64 exec, 0xffff
  s_mov_b32 s46, 0
L_poll_24:
  buffer_load_dwordx2 v[6:7], v8, s[28:31], s83 offen sc1
  s_add_u32 s46, s46, 1
  s_cmp_ge_u32 s46, 131072
  s_waitcnt vmcnt(0)
  s_cbranch_scc1 L_poll_done_25
  v_cmp_ne_u32 vcc, s40, v6
  v_cmp_ne_u32 s[56:57], s41, v7
  s_nop 1
  s_or_b64 vcc, vcc, s[56:57]
  s_cbranch_vccnz L_poll_24
L_poll_done_25:
  s_mov_b64 exec, -1
L_sync_skip_23:
  s_barrier
  s_add_u32 m0, s85, 73856
  s_nop 0
  buffer_load_dwordx4 v2, s[28:31], s84 offen sc1 lds
  buffer_load_dwordx4 v2, s[28:31], s84 offen offset:1024 sc1 lds
  buffer_load_dwordx4 v2, s[28:31], s84 offen offset:2048 sc1 lds
  buffer_load_dwordx4 v2, s[28:31], s84 offen offset:3072 sc1 lds
  s_add_u32 m0, s85, 90240
  s_add_u32 s53, s84, 4096
  buffer_load_dwordx4 v2, s[28:31], s53 offen sc1 lds
  buffer_load_dwordx4 v2, s[28:31], s53 offen offset:1024 sc1 lds
  buffer_load_dwordx4 v2, s[28:31], s53 offen offset:2048 sc1 lds
  buffer_load_dwordx4 v2, s[28:31], s53 offen offset:3072 sc1 lds
  s_waitcnt vmcnt(4)
  s_barrier
  s_add_u32 m0, s85, 106624
  s_add_u32 s53, s84, 8192
  buffer_load_dwordx4 v2, s[28:31], s53 offen sc1 lds
  buffer_load_dwordx4 v2, s[28:31], s53 offen offset:1024 sc1 lds
  buffer_load_dwordx4 v2, s[28:31], s53 offen offset:2048 sc1 lds
  buffer_load_dwordx4 v2, s[28:31], s53 offen offset:3072 sc1 lds
  s_add_u32 m0, s67, 24608
  s_add_u32 s53, s66, 352256
  buffer_load_dwordx4 v20, s[16:19], s53 offen  lds
  s_add_u32 m0, s67, 25632
  s_add_u32 s53, s66, 352256
  buffer_load_dwordx4 v21, s[16:19], s53 offen  lds
  s_add_u32 m0, s67, 26656
  s_add_u32 s53, s66, 352256
  buffer_load_dwordx4 v22, s[16:19], s53 offen  lds
  s_add_u32 m0, s67, 36928
  s_add_u32 s53, s66, 352256
  buffer_load_dwordx4 v20, s[92:95], s53 offen  lds
  s_add_u32 m0, s67, 37952
  s_add_u32 s53, s66, 352256
  buffer_load_dwordx4 v21, s[92:95], s53 offen  lds
  s_add_u32 m0, s67, 38976
  s_add_u32 s53, s66, 352256
  buffer_load_dwordx4 v22, s[92:95], s53 offen  lds
  s_waitcnt vmcnt(10)
  s_barrier
  s_add_u32 m0, s85, 73856
  s_add_u32 s53, s84, 12288
  buffer_load_dwordx4 v2, s[28:31], s53 offen sc1 lds
  buffer_load_dwordx4 v2, s[28:31], s53 offen offset:1024 sc1 lds
  buffer_load_dwordx4 v2, s[28:31], s53 offen offset:2048 sc1 lds
  buffer_load_dwordx4 v2, s[28:31], s53 offen offset:3072 sc1 lds
  s_add_u32 m0, s67, 49216
  s_add_u32 s53, s66, 528384
  buffer_load_dwordx4 v20, s[16:19], s53 offen  lds
  s_add_u32 m0, s67, 50240
  s_add_u32 s53, s66, 528384
  buffer_load_dwordx4 v21, s[16:19], s53 offen  lds
  s_add_u32 m0, s67, 51264
  s_add_u32 s53, s66, 528384
  buffer_load_dwordx4 v22, s[16:19], s53 offen  lds
  s_add_u32 m0, s67, 61536
  s_add_u32 s53, s66, 528384
  buffer_load_dwordx4 v20, s[92:95], s53 offen  lds
  s_add_u32 m0, s67, 62560
  s_add_u32 s53, s66, 528384
  buffer_load_dwordx4 v21, s[92:95], s53 offen  lds
  s_add_u32 m0, s67, 63584
  s_add_u32 s53, s66, 528384
  buffer_load_dwordx4 v22, s[92:95], s53 offen  lds
  s_waitcnt vmcnt(10)
  s_barrier
  s_add_u32 m0, s85, 90240
  s_add_u32 s53, s84, 16384
  buffer_load_dwordx4 v2, s[28:31], s53 offen sc1 lds
  buffer_load_dwordx4 v2, s[28:31], s53 offen offset:1024 sc1 lds
  buffer_load_dwordx4 v2, s[28:31], s53 offen offset:2048 sc1 lds
  buffer_load_dwordx4 v2, s[28:31], s53 offen offset:3072 sc1 lds
  s_add_u32 m0, s67, 131072
  s_add_u32 s53, s66, 704512
  buffer_load_dwordx4 v20, s[16:19], s53 offen  lds
  s_add_u32 m0, s67, 132096
  s_add_u32 s53, s66, 704512
  buffer_load_dwordx4 v21, s[16:19], s53 offen  lds
  s_add_u32 m0, s67, 133120
  s_add_u32 s53, s66, 704512
  buffer_load_dwordx4 v22, s[16:19], s53 offen  lds
  s_add_u32 m0, s67, 143392
  s_add_u32 s53, s66, 704512
  buffer_load_dwordx4 v20, s[92:95], s53 offen  lds
  s_add_u32 m0, s67, 144416
  s_add_u32 s53, s66, 704512
  buffer_load_dwordx4 v21, s[92:95], s53 offen  lds
  s_add_u32 m0, s67, 145440
  s_add_u32 s53, s66, 704512
  buffer_load_dwordx4 v22, s[92:95], s53 offen  lds
  s_waitcnt vmcnt(10)
  s_barrier
  s_add_u32 m0, s85, 106624
  s_add_u32 s53, s84, 20480
  buffer_load_dwordx4 v2, s[28:31], s53 offen sc1 lds
  buffer_load_dwordx4 v2, s[28:31], s53 offen offset:1024 sc1 lds
  buffer_load_dwordx4 v2, s[28:31], s53 offen offset:2048 sc1 lds
  buffer_load_dwordx4 v2, s[28:31], s53 offen offset:3072 sc1 lds
  s_mov_b32 m0, s67
  s_add_u32 s53, s66, 880640
  buffer_load_dwordx4 v20, s[16:19], s53 offen  lds
  s_add_u32 m0, s67, 1024
  s_add_u32 s53, s66, 880640
  buffer_load_dwordx4 v21, s[16:19], s53 offen  lds
  s_add_u32 m0, s67, 2048
  s_add_u32 s53, s66, 880640
  buffer_load_dwordx4 v22, s[16:19], s53 offen  lds
  s_add_u32 m0, s67, 12320
  s_add_u32 s53, s66, 880640
  buffer_load_dwordx4 v20, s[92:95], s53 offen  lds
  s_add_u32 m0, s67, 13344
  s_add_u32 s53, s66, 880640
  buffer_load_dwordx4 v21, s[92:95], s53 offen  lds
  s_add_u32 m0, s67, 14368
  s_add_u32 s53, s66, 880640
  buffer_load_dwordx4 v22, s[92:95], s53 offen  lds
  s_waitcnt vmcnt(10)
  s_barrier
  s_add_u32 m0, s85, 73856
  s_add_u32 s53, s84, 24576
  buffer_load_dwordx4 v2, s[28:31], s53 offen sc1 lds
  buffer_load_dwordx4 v2, s[28:31], s53 offen offset:1024 sc1 lds
  buffer_load_dwordx4 v2, s[28:31], s53 offen offset:2048 sc1 lds
  buffer_load_dwordx4 v2, s[28:31], s53 offen offset:3072 sc1 lds
  s_add_u32 m0, s67, 24608
  s_add_u32 s53, s66, 1056768
  buffer_load_dwordx4 v20, s[16:19], s53 offen  lds
  s_add_u32 m0, s67, 25632
  s_add_u32 s53, s66, 1056768
  buffer_load_dwordx4 v21, s[16:19], s53 offen  lds
  s_add_u32 m0, s67, 26656
  s_add_u32 s53, s66, 1056768
  buffer_load_dwordx4 v22, s[16:19], s53 offen  lds
  s_add_u32 m0, s67, 36928
  s_add_u32 s53, s66, 1056768
  buffer_load_dwordx4 v20, s[92:95], s53 offen  lds
  s_add_u32 m0, s67, 37952
  s_add_u32 s53, s66, 1056768
  buffer_load_dwordx4 v21, s[92:95], s53 offen  lds
  s_add_u32 m0, s67, 38976
  s_add_u32 s53, s66, 1056768
  buffer_load_dwordx4 v22, s[92:95], s53 offen  lds
  s_waitcnt vmcnt(10)
  s_barrier
  s_add_u32 m0, s85, 90240
  s_add_u32 s53, s84, 28672
  buffer_load_dwordx4 v2, s[28:31], s53 offen sc1 lds
  buffer_load_dwordx4 v2, s[28:31], s53 offen offset:1024 sc1 lds
  buffer_load_dwordx4 v2, s[28:31], s53 offen offset:2048 sc1 lds
  buffer_load_dwordx4 v2, s[28:31], s53 offen offset:3072 sc1 lds
  s_add_u32 m0, s67, 49216
  s_add_u32 s53, s66, 1232896
  buffer_load_dwordx4 v20, s[16:19], s53 offen  lds
  s_add_u32 m0, s67, 50240
  s_add_u32 s53, s66, 1232896
  buffer_load_dwordx4 v21, s[16:19], s53 offen  lds
  s_add_u32 m0, s67, 51264
  s_add_u32 s53, s66, 1232896
  buffer_load_dwordx4 v22, s[16:19], s53 offen  lds
  s_add_u32 m0, s67, 61536
  s_add_u32 s53, s66, 1232896
  buffer_load_dwordx4 v20, s[92:95], s53 offen  lds
  s_add_u32 m0, s67, 62560
  s_add_u32 s53, s66, 1232896
  buffer_load_dwordx4 v21, s[92:95], s53 offen  lds
  s_add_u32 m0, s67, 63584
  s_add_u32 s53, s66, 1232896
  buffer_load_dwordx4 v22, s[92:95], s53 offen  lds
  s_waitcnt vmcnt(10)
  s_barrier
  s_and_b32 s44, s37, 1
  s_lshl_b32 s44, s44, 1
  s_lshr_b32 s45, s38, 3
  s_add_u32 s44, s44, s45
  s_lshl_b32 s44, s44, 2
  s_add_u32 s44, s44, s78
  s_lshr_b32 s45, s44, 3
  s_mul_i32 s45, s45, 688
  s_and_b32 s44, s44, 7
  s_mul_i32 s44, s44, 46
  s_add_u32 s44, s44, s45
  s_add_u32 s44, s44, 320
  s_lshl_b32 s44, s44, 10
  s_and_b32 s45, s38, 7
  s_lshl_b32 s45, s45, 7
  s_add_u32 s44, s44, s45
  s_mov_b32 exec_lo, -1
  s_mov_b32 exec_hi, 0x3fff
  buffer_load_dword v24, v25, s[20:23], s44 offen
  s_mov_b64 exec, -1
  s_waitcnt vmcnt(1)
  s_barrier
  s_barrier
  s_mov_b32 m0, s75
  s_nop 0
  buffer_load_dwordx4 v19, s[20:23], s74 offen  lds
  s_add_u32 m0, s75, 1024
  s_add_u32 s53, s74, 8192
  buffer_load_dwordx4 v19, s[20:23], s53 offen  lds
  s_add_u32 m0, s75, 2048
  s_add_u32 s53, s74, 16384
  buffer_load_dwordx4 v19, s[20:23], s53 offen  lds
  s_add_u32 m0, s75, 3072
  s_add_u32 s53, s74, 24576
  buffer_load_dwordx4 v19, s[20:23], s53 offen  lds
  s_add_u32 m0, s75, 16384
  s_add_u32 s53, s74, 65536
  buffer_load_dwordx4 v19, s[20:23], s53 offen  lds
  s_add_u32 m0, s75, 17408
  s_add_u32 s53, s74, 73728
  buffer_load_dwordx4 v19, s[20:23], s53 offen  lds
  s_add_u32 m0, s75, 18432
  s_add_u32 s53, s74, 81920
  buffer_load_dwordx4 v19, s[20:23], s53 offen  lds
  s_add_u32 m0, s75, 19456
  s_add_u32 s53, s74, 90112
  buffer_load_dwordx4 v19, s[20:23], s53 offen  lds
  s_add_u32 m0, s75, 32768
  s_add_u32 s53, s74, 131072
  buffer_load_dwordx4 v19, s[20:23], s53 offen  lds
  s_add_u32 m0, s75, 33792
  s_add_u32 s53, s74, 139264
  buffer_load_dwordx4 v19, s[20:23], s53 offen  lds
  s_add_u32 m0, s75, 34816
  s_add_u32 s53, s74, 147456
  buffer_load_dwordx4 v19, s[20:23], s53 offen  lds
  s_add_u32 m0, s75, 35840
  s_add_u32 s53, s74, 155648
  buffer_load_dwordx4 v19, s[20:23], s53 offen  lds
  s_add_u32 m0, s75, 49152
  s_add_u32 s53, s74, 196608
  buffer_load_dwordx4 v19, s[20:23], s53 offen  lds
  s_add_u32 m0, s75, 50176
  s_add_u32 s53, s74, 204800
  buffer_load_dwordx4 v19, s[20:23], s53 offen  lds
  s_add_u32 m0, s75, 51200
  s_add_u32 s53, s74, 212992
  buffer_load_dwordx4 v19, s[20:23], s53 offen  lds
  s_add_u32 m0, s75, 52224
  s_add_u32 s53, s74, 221184
  buffer_load_dwordx4 v19, s[20:23], s53 offen  lds
  s_add_u32 m0, s75, 65536
  s_add_u32 s53, s74, 262144
  buffer_load_dwordx4 v19, s[20:23], s53 offen  lds
  s_add_u32 m0, s75, 66560
  s_add_u32 s53, s74, 270336
  buffer_load_dwordx4 v19, s[20:23], s53 offen  lds
  s_add_u32 m0, s75, 67584
  s_add_u32 s53, s74, 278528
  buffer_load_dwordx4 v19, s[20:23], s53 offen  lds
  s_add_u32 m0, s75, 68608
  s_add_u32 s53, s74, 286720
  buffer_load_dwordx4 v19, s[20:23], s53 offen  lds
  s_lshl_b32 s44, s37, 2
  s_lshr_b32 s45, s38, 3
  s_lshl_b32 s45, s45, 1
  s_add_u32 s44, s44, s45
  s_and_b32 s45, s78, 1
  s_add_u32 s44, s44, s45
  s_mul_i32 s44, s44, 86
  s_lshr_b32 s46, s78, 1
  s_mul_i32 s47, s46, 43
  s_add_u32 s44, s44, s47
  s_lshl_b32 s86, s44, 10
  s_add_u32 s86, s86, 8650752
  s_lshl_b32 s87, s78, 12
  s_lshl_b32 s82, s37, 11
  s_lshl_b32 s52, s38, 7
  s_add_u32 s82, s82, s52
  s_add_u32 s82, s82, 135168
  s_lshl_b32 s83, s37, 11
  s_add_u32 s83, s83, 135168
  v_mov_b32 v4, s40
  v_mov_b32 v5, s41
  v_lshlrev_b32 v8, 3, v2
  s_barrier
  s_cmp_lg_u32 s36, 8
  s_cbranch_scc1 L_sync_skip_37
  s_mov_b64 exec, 1
  s_cmp_eq_u32 s39, 0
  s_cbranch_scc1 L_flag_slow_40
  buffer_store_dwordx2 v[4:5], off, s[28:31], s82
  s_branch L_flag_posted_41
L_flag_slow_40:
  buffer_store_dwordx2 v[4:5], off, s[28:31], s82 sc1
L_flag_posted_41:
  s_mov_b64 exec, -1
  s_mov_b64 exec, 0xffff
  s_mov_b32 s46, 0
L_poll_38:
  buffer_load_dwordx2 v[6:7], v8, s[28:31], s83 offen sc1
  s_add_u32 s46, s46, 1
  s_cmp_ge_u32 s46, 131072
  s_waitcnt vmcnt(0)
  s_cbranch_scc1 L_poll_done_39
  v_cmp_ne_u32 vcc, s40, v6
  v_cmp_ne_u32 s[56:57], s41, v7
  s_nop 1
  s_or_b64 vcc, vcc, s[56:57]
  s_cbranch_vccnz L_poll_38
L_poll_done_39:
  s_mov_b64 exec, -1
L_sync_skip_37:
  s_barrier
  s_add_u32 m0, s87, 98304
  s_nop 0
  buffer_load_dwordx4 v2, s[28:31], s86 offen sc1 lds
  buffer_load_dwordx4 v2, s[28:31], s86 offen offset:1024 sc1 lds
  buffer_load_dwordx4 v2, s[28:31], s86 offen offset:2048 sc1 lds
  buffer_load_dwordx4 v2, s[28:31], s86 offen offset:3072 sc1 lds
  s_add_u32 m0, s87, 114688
  s_add_u32 s53, s86, 4096
  buffer_load_dwordx4 v2, s[28:31], s53 offen sc1 lds
  buffer_load_dwordx4 v2, s[28:31], s53 offen offset:1024 sc1 lds
  buffer_load_dwordx4 v2, s[28:31], s53 offen offset:2048 sc1 lds
  buffer_load_dwordx4 v2, s[28:31], s53 offen offset:3072 sc1 lds
  s_add_u32 m0, s75, 81920
  s_add_u32 s53, s74, 327680
  buffer_load_dwordx4 v19, s[20:23], s53 offen  lds
  s_add_u32 m0, s75, 82944
  s_add_u32 s53, s74, 335872
  buffer_load_dwordx4 v19, s[20:23], s53 offen  lds
  s_add_u32 m0, s75, 83968
  s_add_u32 s53, s74, 344064
  buffer_load_dwordx4 v19, s[20:23], s53 offen  lds
  s_add_u32 m0, s75, 84992
  s_add_u32 s53, s74, 352256
  buffer_load_dwordx4 v19, s[20:23], s53 offen  lds
  s_waitcnt vmcnt(8)
  s_barrier
  s_add_u32 m0, s87, 131072
  s_add_u32 s53, s86, 8192
  buffer_load_dwordx4 v2, s[28:31], s53 offen sc1 lds
  buffer_load_dwordx4 v2, s[28:31], s53 offen offset:1024 sc1 lds
  buffer_load_dwordx4 v2, s[28:31], s53 offen offset:2048 sc1 lds
  buffer_load_dwordx4 v2, s[28:31], s53 offen offset:3072 sc1 lds
  s_waitcnt vmcnt(8)
  s_barrier
  s_add_u32 m0, s87, 98304
  s_add_u32 s53, s86, 12288
  buffer_load_dwordx4 v2, s[28:31], s53 offen sc1 lds
  buffer_load_dwordx4 v2, s[28:31], s53 offen offset:1024 sc1 lds
  buffer_load_dwordx4 v2, s[28:31], s53 offen offset:2048 sc1 lds
  buffer_load_dwordx4 v2, s[28:31], s53 offen offset:3072 sc1 lds
  s_mov_b32 m0, s75
  s_add_u32 s53, s74, 393216
  buffer_load_dwordx4 v19, s[20:23], s53 offen  lds
  s_add_u32 m0, s75, 1024
  s_add_u32 s53, s74, 401408
  buffer_load_dwordx4 v19, s[20:23], s53 offen  lds
  s_add_u32 m0, s75, 2048
  s_add_u32 s53, s74, 409600
  buffer_load_dwordx4 v19, s[20:23], s53 offen  lds
  s_add_u32 m0, s75, 3072
  s_add_u32 s53, s74, 417792
  buffer_load_dwordx4 v19, s[20:23], s53 offen  lds
  s_waitcnt vmcnt(8)
  s_barrier
  s_add_u32 m0, s87, 114688
  s_add_u32 s53, s86, 16384
  buffer_load_dwordx4 v2, s[28:31], s53 offen sc1 lds
  buffer_load_dwordx4 v2, s[28:31], s53 offen offset:1024 sc1 lds
  buffer_load_dwordx4 v2, s[28:31], s53 offen offset:2048 sc1 lds
  buffer_load_dwordx4 v2, s[28:31], s53 offen offset:3072 sc1 lds
  s_add_u32 m0, s75, 16384
  s_add_u32 s53, s74, 458752
  buffer_load_dwordx4 v19, s[20:23], s53 offen  lds
  s_add_u32 m0, s75, 17408
  s_add_u32 s53, s74, 466944
  buffer_load_dwordx4 v19, s[20:23], s53 offen  lds
  s_add_u32 m0, s75, 18432
  s_add_u32 s53, s74, 475136
  buffer_load_dwordx4 v19, s[20:23], s53 offen  lds
  s_add_u32 m0, s75, 19456
  s_add_u32 s53, s74, 483328
  buffer_load_dwordx4 v19, s[20:23], s53 offen  lds
  s_waitcnt vmcnt(12)
  s_barrier
  s_add_u32 m0, s87, 131072
  s_add_u32 s53, s86, 20480
  buffer_load_dwordx4 v2, s[28:31], s53 offen sc1 lds
  buffer_load_dwordx4 v2, s[28:31], s53 offen offset:1024 sc1 lds
  buffer_load_dwordx4 v2, s[28:31], s53 offen offset:2048 sc1 lds
  buffer_load_dwordx4 v2, s[28:31], s53 offen offset:3072 sc1 lds
  s_add_u32 m0, s75, 32768
  s_add_u32 s53, s74, 524288
  buffer_load_dwordx4 v19, s[20:23], s53 offen  lds
  s_add_u32 m0, s75, 33792
  s_add_u32 s53, s74, 532480
  buffer_load_dwordx4 v19, s[20:23], s53 offen  lds
  s_add_u32 m0, s75, 34816
  s_add_u32 s53, s74, 540672
  buffer_load_dwordx4 v19, s[20:23], s53 offen  lds
  s_add_u32 m0, s75, 35840
  s_add_u32 s53, s74, 548864
  buffer_load_dwordx4 v19, s[20:23], s53 offen  lds
  s_waitcnt vmcnt(12)
  s_barrier
  s_add_u32 m0, s87, 98304
  s_add_u32 s53, s86, 24576
  buffer_load_dwordx4 v2, s[28:31], s53 offen sc1 lds
  buffer_load_dwordx4 v2, s[28:31], s53 offen offset:1024 sc1 lds
  buffer_load_dwordx4 v2, s[28:31], s53 offen offset:2048 sc1 lds
  buffer_load_dwordx4 v2, s[28:31], s53 offen offset:3072 sc1 lds
  s_add_u32 m0, s75, 49152
  s_add_u32 s53, s74, 589824
  buffer_load_dwordx4 v19, s[20:23], s53 offen  lds
  s_add_u32 m0, s75, 50176
  s_add_u32 s53, s74, 598016
  buffer_load_dwordx4 v19, s[20:23], s53 offen  lds
  s_add_u32 m0, s75, 51200
  s_add_u32 s53, s74, 606208
  buffer_load_dwordx4 v19, s[20:23], s53 offen  lds
  s_add_u32 m0, s75, 52224
  s_add_u32 s53, s74, 614400
  buffer_load_dwordx4 v19, s[20:23], s53 offen  lds
  s_waitcnt vmcnt(12)
  s_barrier
  s_add_u32 m0, s87, 114688
  s_add_u32 s53, s86, 28672
  buffer_load_dwordx4 v2, s[28:31], s53 offen sc1 lds
  buffer_load_dwordx4 v2, s[28:31], s53 offen offset:1024 sc1 lds
  buffer_load_dwordx4 v2, s[28:31], s53 offen offset:2048 sc1 lds
  buffer_load_dwordx4 v2, s[28:31], s53 offen offset:3072 sc1 lds
  s_add_u32 m0, s75, 65536
  s_add_u32 s53, s74, 655360
  buffer_load_dwordx4 v19, s[20:23], s53 offen  lds
  s_add_u32 m0, s75, 66560
  s_add_u32 s53, s74, 663552
  buffer_load_dwordx4 v19, s[20:23], s53 offen  lds
  s_add_u32 m0, s75, 67584
  s_add_u32 s53, s74, 671744
  buffer_load_dwordx4 v19, s[20:23], s53 offen  lds
  s_add_u32 m0, s75, 68608
  s_add_u32 s53, s74, 679936
  buffer_load_dwordx4 v19, s[20:23], s53 offen  lds
  s_waitcnt vmcnt(12)
  s_barrier
  s_add_u32 m0, s87, 131072
  s_add_u32 s53, s86, 32768
  buffer_load_dwordx4 v2, s[28:31], s53 offen sc1 lds
  buffer_load_dwordx4 v2, s[28:31], s53 offen offset:1024 sc1 lds
  buffer_load_dwordx4 v2, s[28:31], s53 offen offset:2048 sc1 lds
  buffer_load_dwordx4 v2, s[28:31], s53 offen offset:3072 sc1 lds
  s_waitcnt vmcnt(8)
  s_barrier
  s_add_u32 m0, s87, 98304
  s_add_u32 s53, s86, 36864
  buffer_load_dwordx4 v2, s[28:31], s53 offen sc1 lds
  buffer_load_dwordx4 v2, s[28:31], s53 offen offset:1024 sc1 lds
  buffer_load_dwordx4 v2, s[28:31], s53 offen offset:2048 sc1 lds
  buffer_load_dwordx4 v2, s[28:31], s53 offen offset:3072 sc1 lds
  s_waitcnt vmcnt(4)
  s_barrier
  s_add_u32 m0, s87, 114688
  s_add_u32 s53, s86, 40960
  buffer_load_dwordx4 v2, s[28:31], s53 offen sc1 lds
  buffer_load_dwordx4 v2, s[28:31], s53 offen offset:1024 sc1 lds
  buffer_load_dwordx4 v2, s[28:31], s53 offen offset:2048 sc1 lds
  buffer_load_dwordx4 v2, s[28:31], s53 offen offset:3072 sc1 lds
  s_waitcnt vmcnt(4)
  s_barrier
  s_waitcnt vmcnt(0)
  s_barrier
  s_barrier
  s_waitcnt vmcnt(0)
  s_endpgm
L_compute:
  s_lshr_b32 s69, s36, 2
  s_lshl_b32 s69, s69, 1
  s_add_u32 s69, s69, s36
  v_and_b32 v4, 31, v1
  v_lshlrev_b32 v4, 7, v4
  v_bfe_u32 v5, v1, 1, 3
  v_lshrrev_b32 v6, 5, v1
  v_xor_b32 v5, v5, v6
  v_lshl_add_u32 v4, v5, 4, v4
  s_and_b32 s44, s36, 3
  s_lshl_b32 s44, s44, 12
  v_add_u32 v4, s44, v4
  v_lshlrev_b32 v6, 3, v6
  v_bfe_u32 v5, v1, 2, 2
  v_add_u32 v6, v6, v5
  v_lshlrev_b32 v6, 6, v6
  v_bfe_u32 v5, v1, 4, 1
  v_lshl_add_u32 v6, v5, 5, v6
  v_and_b32 v5, 3, v1
  v_lshl_add_u32 v5, v5, 3, v6
  s_add_u32 s44, s69, 0
  s_and_b32 s44, s44, 3
  s_lshl_b32 s45, s44, 5
  s_lshl_b32 s44, s44, 10
  v_xor_b32 v7, s45, v4
  v_add_u32 v11, s44, v5
  s_add_u32 s44, s69, 1
  s_and_b32 s44, s44, 3
  s_lshl_b32 s45, s44, 5
  s_lshl_b32 s44, s44, 10
  v_xor_b32 v8, s45, v4
  v_add_u32 v12, s44, v5
  s_add_u32 s44, s69, 2
  s_and_b32 s44, s44, 3
  s_lshl_b32 s45, s44, 5
  s_lshl_b32 s44, s44, 10
  v_xor_b32 v9, s45, v4
  v_add_u32 v13, s44, v5
  s_add_u32 s44, s69, 3
  s_and_b32 s44, s44, 3
  s_lshl_b32 s45, s44, 5
  s_lshl_b32 s44, s44, 10
  v_xor_b32 v10, s45, v4
  v_add_u32 v14, s44, v5
  s_cmp_lg_u32 s36, 0
  s_cbranch_scc1 L_codepf
  s_getpc_b64 s[46:47]
L_pc_here:
  s_sub_u32 s46, s46, L_pc_here-sequential_preLN__softmax_full_mha__swiglu_ffn__prompt_kernel
  s_subb_u32 s47, s47, 0
  s_lshr_b32 s44, s2, 3
  s_lshl_b32 s44, s44, 11
  v_lshlrev_b32 v5, 7, v1
  v_add_u32 v5, s44, v5
  s_mov_b32 s45, L_end-sequential_preLN__softmax_full_mha__swiglu_ffn__prompt_kernel
  v_cmp_gt_u32 vcc, s45, v5
  s_nop 0
  s_and_b32 vcc_lo, vcc_lo, 0xffff
  s_mov_b32 vcc_hi, 0
  s_and_saveexec_b64 s[56:57], vcc
  s_cbranch_execz L_codepf_r
  global_load_dword v6, v5, s[46:47]
L_codepf_r:
  s_mov_b64 exec, s[56:57]
L_codepf:
  v_and_b32 v16, 15, v1
  v_bfe_u32 v5, v1, 4, 1
  v_cmp_eq_u32 vcc, v16, v5
  v_mov_b32 v5, 0x3f803f80
  s_nop 0
  v_cndmask_b32 v16, 0, v5, vcc
  v_mov_b32 v17, v16
  v_mov_b32 v18, v16
  v_mov_b32 v19, v16
  v_mov_b32 v15, 0xffff0000
  v_mov_b32 v24, 0
  v_mov_b32 v25, 0
  v_mov_b32 v26, 0
  v_mov_b32 v27, 0
  s_mov_b32 s54, 0x0000ffff
  s_mov_b32 s55, 0x0000ffff
  s_waitcnt lgkmcnt(0)
  s_cmp_ge_u32 s36, 4
  s_cbranch_scc1 L_p1_roleB
  v_and_b32 v98, 31, v1
  s_and_b32 s44, s36, 3
  s_lshl_b32 s44, s44, 7
  s_add_u32 s44, s44, 143360
  v_lshlrev_b32 v98, 2, v98
  v_add_u32 v98, s44, v98
  v_and_b32 v99, 1, v1
  v_lshlrev_b32 v99, 6, v99
  v_lshrrev_b32 v96, 4, v1
  v_lshl_add_u32 v99, v96, 4, v99
  s_lshl_b32 s44, s36, 8
  s_add_u32 s45, s44, 145408
  v_add_u32 v99, s45, v99
  v_and_b32 v97, 31, v1
  v_lshlrev_b32 v97, 2, v97
  v_add_u32 v97, 145408, v97
  v_add_u32 v100, s44, v97
  v_lshrrev_b32 v101, 5, v1
  v_lshlrev_b32 v101, 4, v101
  s_add_u32 s44, s44, 146432
  v_add_u32 v101, s44, v101
  s_lshl_b32 s62, s37, 17
  s_lshl_b32 s45, s38, 12
  s_add_u32 s62, s62, s45
  s_lshl_b32 s45, s36, 10
  s_add_u32 s62, s62, s45
  s_add_u32 s62, s62, 262144
  s_add_u32 s63, s62, 65536
  s_lshl_b32 s44, s36, 10
  v_add_u32 v102, s44, v2
  s_barrier
  ds_read_b128 v[64:67], v7 offset:0
  ds_read_b64_tr_b16 v[72:73], v11 offset:16384
  ds_read_b64_tr_b16 v[74:75], v11 offset:16640
  ds_read_b64_tr_b16 v[80:81], v11 offset:20480
  ds_read_b64_tr_b16 v[82:83], v11 offset:20736
  s_waitcnt lgkmcnt(0)
  v_mfma_f32_32x32x16_bf16 v[32:47], v[72:75], v[64:67], 0
  ds_read_b128 v[68:71], v8 offset:0
  ds_read_b64_tr_b16 v[76:77], v12 offset:16384
  ds_read_b64_tr_b16 v[78:79], v12 offset:16640
  ds_read_b64_tr_b16 v[84:85], v12 offset:20480
  ds_read_b64_tr_b16 v[86:87], v12 offset:20736
  v_mfma_f32_32x32x16_bf16 v[48:63], v[80:83], v[64:67], 0
  v_mfma_f32_16x16x32_bf16 v[88:91], v[72:75], v[16:19], 0
  s_waitcnt lgkmcnt(0)
  v_mfma_f32_32x32x16_bf16 v[32:47], v[76:79], v[68:71], v[32:47]
  ds_read_b128 v[64:67], v9 offset:0
  ds_read_b64_tr_b16 v[72:73], v13 offset:16384
  ds_read_b64_tr_b16 v[74:75], v13 offset:16640
  ds_read_b64_tr_b16 v[80:81], v13 offset:20480
  ds_read_b64_tr_b16 v[82:83], v13 offset:20736
  v_mfma_f32_32x32x16_bf16 v[48:63], v[84:87], v[68:71], v[48:63]
  v_mfma_f32_16x16x32_bf16 v[92:95], v[84:87], v[16:19], 0
  s_waitcnt lgkmcnt(0)
  v_mfma_f32_32x32x16_bf16 v[32:47], v[72:75], v[64:67], v[32:47]
  ds_read_b128 v[68:71], v10 offset:0
  ds_read_b64_tr_b16 v[76:77], v14 offset:16384
  ds_read_b64_tr_b16 v[78:79], v14 offset:16640
  ds_read_b64_tr_b16 v[84:85], v14 offset:20480
  ds_read_b64_tr_b16 v[86:87], v14 offset:20736
  v_mfma_f32_32x32x16_bf16 v[48:63], v[80:83], v[64:67], v[48:63]
  s_waitcnt lgkmcnt(0)
  s_barrier
  v_mfma_f32_32x32x16_bf16 v[32:47], v[76:79], v[68:71], v[32:47]
  ds_read_b128 v[64:67], v7 offset:28672
  ds_read_b64_tr_b16 v[72:73], v11 offset:45056
  ds_read_b64_tr_b16 v[74:75], v11 offset:45312
  ds_read_b64_tr_b16 v[80:81], v11 offset:49152
  ds_read_b64_tr_b16 v[82:83], v11 offset:49408
  v_mfma_f32_32x32x16_bf16 v[48:63], v[84:87], v[68:71], v[48:63]
  s_waitcnt lgkmcnt(0)
  v_mfma_f32_32x32x16_bf16 v[32:47], v[72:75], v[64:67], v[32:47]
  ds_read_b128 v[68:71], v8 offset:28672
  ds_read_b64_tr_b16 v[76:77], v12 offset:45056
  ds_read_b64_tr_b16 v[78:79], v12 offset:45312
  ds_read_b64_tr_b16 v[84:85], v12 offset:49152
  ds_read_b64_tr_b16 v[86:87], v12 offset:49408
  v_mfma_f32_32x32x16_bf16 v[48:63], v[80:83], v[64:67], v[48:63]
  v_mfma_f32_16x16x32_bf16 v[88:91], v[72:75], v[16:19], v[88:91]
  s_waitcnt lgkmcnt(0)
  v_mfma_f32_32x32x16_bf16 v[32:47], v[76:79], v[68:71], v[32:47]
  ds_read_b128 v[64:67], v9 offset:28672
  ds_read_b64_tr_b16 v[72:73], v13 offset:45056
  ds_read_b64_tr_b16 v[74:75], v13 offset:45312
  ds_read_b64_tr_b16 v[80:81], v13 offset:49152
  ds_read_b64_tr_b16 v[82:83], v13 offset:49408
  v_mfma_f32_32x32x16_bf16 v[48:63], v[84:87], v[68:71], v[48:63]
  v_mfma_f32_16x16x32_bf16 v[92:95], v[84:87], v[16:19], v[92:95]
  s_waitcnt lgkmcnt(0)
  v_mfma_f32_32x32x16_bf16 v[32:47], v[72:75], v[64:67], v[32:47]
  ds_read_b128 v[68:71], v10 offset:28672
  ds_read_b64_tr_b16 v[76:77], v14 offset:45056
  ds_read_b64_tr_b16 v[78:79], v14 offset:45312
  ds_read_b64_tr_b16 v[84:85], v14 offset:49152
  ds_read_b64_tr_b16 v[86:87], v14 offset:49408
  v_mfma_f32_32x32x16_bf16 v[48:63], v[80:83], v[64:67], v[48:63]
  s_waitcnt lgkmcnt(0)
  v_add_u32 v7, 57344, v7
  v_add_u32 v8, 57344, v8
  v_add_u32 v9, 57344, v9
  v_add_u32 v10, 57344, v10
  v_add_u32 v11, 57344, v11
  v_add_u32 v12, 57344, v12
  v_add_u32 v13, 57344, v13
  v_add_u32 v14, 57344, v14
  s_barrier
  v_mfma_f32_32x32x16_bf16 v[32:47], v[76:79], v[68:71], v[32:47]
  ds_read_b128 v[64:67], v7 offset:0
  ds_read_b64_tr_b16 v[72:73], v11 offset:16384
  ds_read_b64_tr_b16 v[74:75], v11 offset:16640
  ds_read_b64_tr_b16 v[80:81], v11 offset:20480
  ds_read_b64_tr_b16 v[82:83], v11 offset:20736
  v_mfma_f32_32x32x16_bf16 v[48:63], v[84:87], v[68:71], v[48:63]
  s_waitcnt lgkmcnt(0)
  v_mfma_f32_32x32x16_bf16 v[32:47], v[72:75], v[64:67], v[32:47]
  ds_read_b128 v[68:71], v8 offset:0
  ds_read_b64_tr_b16 v[76:77], v12 offset:16384
  ds_read_b64_tr_b16 v[78:79], v12 offset:16640
  ds_read_b64_tr_b16 v[84:85], v12 offset:20480
  ds_read_b64_tr_b16 v[86:87], v12 offset:20736
  v_mfma_f32_32x32x16_bf16 v[48:63], v[80:83], v[64:67], v[48:63]
  v_mfma_f32_16x16x32_bf16 v[88:91], v[72:75], v[16:19], v[88:91]
  s_waitcnt lgkmcnt(0)
  v_mfma_f32_32x32x16_bf16 v[32:47], v[76:79], v[68:71], v[32:47]
  ds_read_b128 v[64:67], v9 offset:0
  ds_read_b64_tr_b16 v[72:73], v13 offset:16384
  ds_read_b64_tr_b16 v[74:75], v13 offset:16640
  ds_read_b64_tr_b16 v[80:81], v13 offset:20480
  ds_read_b64_tr_b16 v[82:83], v13 offset:20736
  v_mfma_f32_32x32x16_bf16 v[48:63], v[84:87], v[68:71], v[48:63]
  v_mfma_f32_16x16x32_bf16 v[92:95], v[84:87], v[16:19], v[92:95]
  s_waitcnt lgkmcnt(0)
  v_mfma_f32_32x32x16_bf16 v[32:47], v[72:75], v[64:67], v[32:47]
  ds_read_b128 v[68:71], v10 offset:0
  ds_read_b64_tr_b16 v[76:77], v14 offset:16384
  ds_read_b64_tr_b16 v[78:79], v14 offset:16640
  ds_read_b64_tr_b16 v[84:85], v14 offset:20480
  ds_read_b64_tr_b16 v[86:87], v14 offset:20736
  v_mfma_f32_32x32x16_bf16 v[48:63], v[80:83], v[64:67], v[48:63]
  s_waitcnt lgkmcnt(0)
  s_barrier
  v_mfma_f32_32x32x16_bf16 v[32:47], v[76:79], v[68:71], v[32:47]
  ds_read_b128 v[64:67], v7 offset:28672
  ds_read_b64_tr_b16 v[72:73], v11 offset:45056
  ds_read_b64_tr_b16 v[74:75], v11 offset:45312
  ds_read_b64_tr_b16 v[80:81], v11 offset:49152
  ds_read_b64_tr_b16 v[82:83], v11 offset:49408
  v_mfma_f32_32x32x16_bf16 v[48:63], v[84:87], v[68:71], v[48:63]
  s_waitcnt lgkmcnt(0)
  v_mfma_f32_32x32x16_bf16 v[32:47], v[72:75], v[64:67], v[32:47]
  ds_read_b128 v[68:71], v8 offset:28672
  ds_read_b64_tr_b16 v[76:77], v12 offset:45056
  ds_read_b64_tr_b16 v[78:79], v12 offset:45312
  ds_read_b64_tr_b16 v[84:85], v12 offset:49152
  ds_read_b64_tr_b16 v[86:87], v12 offset:49408
  v_mfma_f32_32x32x16_bf16 v[48:63], v[80:83], v[64:67], v[48:63]
  v_mfma_f32_16x16x32_bf16 v[88:91], v[72:75], v[16:19], v[88:91]
  s_waitcnt lgkmcnt(0)
  v_mfma_f32_32x32x16_bf16 v[32:47], v[76:79], v[68:71], v[32:47]
  ds_read_b128 v[64:67], v9 offset:28672
  ds_read_b64_tr_b16 v[72:73], v13 offset:45056
  ds_read_b64_tr_b16 v[74:75], v13 offset:45312
  ds_read_b64_tr_b16 v[80:81], v13 offset:49152
  ds_read_b64_tr_b16 v[82:83], v13 offset:49408
  v_mfma_f32_32x32x16_bf16 v[48:63], v[84:87], v[68:71], v[48:63]
  v_mfma_f32_16x16x32_bf16 v[92:95], v[84:87], v[16:19], v[92:95]
  s_waitcnt lgkmcnt(0)
  v_mfma_f32_32x32x16_bf16 v[32:47], v[72:75], v[64:67], v[32:47]
  ds_read_b128 v[68:71], v10 offset:28672
  ds_read_b64_tr_b16 v[76:77], v14 offset:45056
  ds_read_b64_tr_b16 v[78:79], v14 offset:45312
  ds_read_b64_tr_b16 v[84:85], v14 offset:49152
  ds_read_b64_tr_b16 v[86:87], v14 offset:49408
  v_mfma_f32_32x32x16_bf16 v[48:63], v[80:83], v[64:67], v[48:63]
  s_waitcnt lgkmcnt(0)
  v_add_u32 v7, 57344, v7
  v_add_u32 v8, 57344, v8
  v_add_u32 v9, 57344, v9
  v_add_u32 v10, 57344, v10
  v_add_u32 v11, 57344, v11
  v_add_u32 v12, 57344, v12
  v_add_u32 v13, 57344, v13
  v_add_u32 v14, 57344, v14
  s_barrier
  v_mfma_f32_32x32x16_bf16 v[32:47], v[76:79], v[68:71], v[32:47]
  ds_read_b128 v[64:67], v7 offset:0
  ds_read_b64_tr_b16 v[72:73], v11 offset:16384
  ds_read_b64_tr_b16 v[74:75], v11 offset:16640
  ds_read_b64_tr_b16 v[80:81], v11 offset:20480
  ds_read_b64_tr_b16 v[82:83], v11 offset:20736
  v_mfma_f32_32x32x16_bf16 v[48:63], v[84:87], v[68:71], v[48:63]
  s_waitcnt lgkmcnt(0)
  v_mfma_f32_32x32x16_bf16 v[32:47], v[72:75], v[64:67], v[32:47]
  ds_read_b128 v[68:71], v8 offset:0
  ds_read_b64_tr_b16 v[76:77], v12 offset:16384
  ds_read_b64_tr_b16 v[78:79], v12 offset:16640
  ds_read_b64_tr_b16 v[84:85], v12 offset:20480
  ds_read_b64_tr_b16 v[86:87], v12 offset:20736
  v_mfma_f32_32x32x16_bf16 v[48:63], v[80:83], v[64:67], v[48:63]
  v_mfma_f32_16x16x32_bf16 v[88:91], v[72:75], v[16:19], v[88:91]
  s_waitcnt lgkmcnt(0)
  v_mfma_f32_32x32x16_bf16 v[32:47], v[76:79], v[68:71], v[32:47]
  ds_read_b128 v[64:67], v9 offset:0
  ds_read_b64_tr_b16 v[72:73], v13 offset:16384
  ds_read_b64_tr_b16 v[74:75], v13 offset:16640
  ds_read_b64_tr_b16 v[80:81], v13 offset:20480
  ds_read_b64_tr_b16 v[82:83], v13 offset:20736
  v_mfma_f32_32x32x16_bf16 v[48:63], v[84:87], v[68:71], v[48:63]
  v_mfma_f32_16x16x32_bf16 v[92:95], v[84:87], v[16:19], v[92:95]
  s_waitcnt lgkmcnt(0)
  v_mfma_f32_32x32x16_bf16 v[32:47], v[72:75], v[64:67], v[32:47]
  ds_read_b128 v[68:71], v10 offset:0
  ds_read_b64_tr_b16 v[76:77], v14 offset:16384
  ds_read_b64_tr_b16 v[78:79], v14 offset:16640
  ds_read_b64_tr_b16 v[84:85], v14 offset:20480
  ds_read_b64_tr_b16 v[86:87], v14 offset:20736
  v_mfma_f32_32x32x16_bf16 v[48:63], v[80:83], v[64:67], v[48:63]
  s_waitcnt lgkmcnt(0)
  v_subrev_u32 v7, 114688, v7
  v_subrev_u32 v8, 114688, v8
  v_subrev_u32 v9, 114688, v9
  v_subrev_u32 v10, 114688, v10
  v_subrev_u32 v11, 114688, v11
  v_subrev_u32 v12, 114688, v12
  v_subrev_u32 v13, 114688, v13
  v_subrev_u32 v14, 114688, v14
  s_barrier
  v_mfma_f32_32x32x16_bf16 v[32:47], v[76:79], v[68:71], v[32:47]
  ds_read_b128 v[64:67], v7 offset:0
  ds_read_b64_tr_b16 v[72:73], v11 offset:16384
  ds_read_b64_tr_b16 v[74:75], v11 offset:16640
  ds_read_b64_tr_b16 v[80:81], v11 offset:20480
  ds_read_b64_tr_b16 v[82:83], v11 offset:20736
  v_mfma_f32_32x32x16_bf16 v[48:63], v[84:87], v[68:71], v[48:63]
  s_waitcnt lgkmcnt(0)
  v_mfma_f32_32x32x16_bf16 v[32:47], v[72:75], v[64:67], v[32:47]
  ds_read_b128 v[68:71], v8 offset:0
  ds_read_b64_tr_b16 v[76:77], v12 offset:16384
  ds_read_b64_tr_b16 v[78:79], v12 offset:16640
  ds_read_b64_tr_b16 v[84:85], v12 offset:20480
  ds_read_b64_tr_b16 v[86:87], v12 offset:20736
  v_mfma_f32_32x32x16_bf16 v[48:63], v[80:83], v[64:67], v[48:63]
  v_mfma_f32_16x16x32_bf16 v[88:91], v[72:75], v[16:19], v[88:91]
  s_waitcnt lgkmcnt(0)
  v_mfma_f32_32x32x16_bf16 v[32:47], v[76:79], v[68:71], v[32:47]
  ds_read_b128 v[64:67], v9 offset:0
  ds_read_b64_tr_b16 v[72:73], v13 offset:16384
  ds_read_b64_tr_b16 v[74:75], v13 offset:16640
  ds_read_b64_tr_b16 v[80:81], v13 offset:20480
  ds_read_b64_tr_b16 v[82:83], v13 offset:20736
  v_mfma_f32_32x32x16_bf16 v[48:63], v[84:87], v[68:71], v[48:63]
  v_mfma_f32_16x16x32_bf16 v[92:95], v[84:87], v[16:19], v[92:95]
  s_waitcnt lgkmcnt(0)
  v_mfma_f32_32x32x16_bf16 v[32:47], v[72:75], v[64:67], v[32:47]
  ds_read_b128 v[68:71], v10 offset:0
  ds_read_b64_tr_b16 v[76:77], v14 offset:16384
  ds_read_b64_tr_b16 v[78:79], v14 offset:16640
  ds_read_b64_tr_b16 v[84:85], v14 offset:20480
  ds_read_b64_tr_b16 v[86:87], v14 offset:20736
  v_mfma_f32_32x32x16_bf16 v[48:63], v[80:83], v[64:67], v[48:63]
  s_waitcnt lgkmcnt(0)
  s_barrier
  v_mfma_f32_32x32x16_bf16 v[32:47], v[76:79], v[68:71], v[32:47]
  ds_read_b128 v[64:67], v7 offset:28672
  ds_read_b64_tr_b16 v[72:73], v11 offset:45056
  ds_read_b64_tr_b16 v[74:75], v11 offset:45312
  ds_read_b64_tr_b16 v[80:81], v11 offset:49152
  ds_read_b64_tr_b16 v[82:83], v11 offset:49408
  v_mfma_f32_32x32x16_bf16 v[48:63], v[84:87], v[68:71], v[48:63]
  s_waitcnt lgkmcnt(0)
  v_mfma_f32_32x32x16_bf16 v[32:47], v[72:75], v[64:67], v[32:47]
  ds_read_b128 v[68:71], v8 offset:28672
  ds_read_b64_tr_b16 v[76:77], v12 offset:45056
  ds_read_b64_tr_b16 v[78:79], v12 offset:45312
  ds_read_b64_tr_b16 v[84:85], v12 offset:49152
  ds_read_b64_tr_b16 v[86:87], v12 offset:49408
  v_mfma_f32_32x32x16_bf16 v[48:63], v[80:83], v[64:67], v[48:63]
  v_mfma_f32_16x16x32_bf16 v[88:91], v[72:75], v[16:19], v[88:91]
  s_waitcnt lgkmcnt(0)
  v_mfma_f32_32x32x16_bf16 v[32:47], v[76:79], v[68:71], v[32:47]
  ds_read_b128 v[64:67], v9 offset:28672
  ds_read_b64_tr_b16 v[72:73], v13 offset:45056
  ds_read_b64_tr_b16 v[74:75], v13 offset:45312
  ds_read_b64_tr_b16 v[80:81], v13 offset:49152
  ds_read_b64_tr_b16 v[82:83], v13 offset:49408
  v_mfma_f32_32x32x16_bf16 v[48:63], v[84:87], v[68:71], v[48:63]
  v_mfma_f32_16x16x32_bf16 v[92:95], v[84:87], v[16:19], v[92:95]
  s_waitcnt lgkmcnt(0)
  v_mfma_f32_32x32x16_bf16 v[32:47], v[72:75], v[64:67], v[32:47]
  ds_read_b128 v[68:71], v10 offset:28672
  ds_read_b64_tr_b16 v[76:77], v14 offset:45056
  ds_read_b64_tr_b16 v[78:79], v14 offset:45312
  ds_read_b64_tr_b16 v[84:85], v14 offset:49152
  ds_read_b64_tr_b16 v[86:87], v14 offset:49408
  v_mfma_f32_32x32x16_bf16 v[48:63], v[80:83], v[64:67], v[48:63]
  s_waitcnt lgkmcnt(0)
  v_add_u32 v7, 57344, v7
  v_add_u32 v8, 57344, v8
  v_add_u32 v9, 57344, v9
  v_add_u32 v10, 57344, v10
  v_add_u32 v11, 57344, v11
  v_add_u32 v12, 57344, v12
  v_add_u32 v13, 57344, v13
  v_add_u32 v14, 57344, v14
  s_barrier
  v_mfma_f32_32x32x16_bf16 v[32:47], v[76:79], v[68:71], v[32:47]
  ds_read_b128 v[64:67], v7 offset:0
  ds_read_b64_tr_b16 v[72:73], v11 offset:16384
  ds_read_b64_tr_b16 v[74:75], v11 offset:16640
  ds_read_b64_tr_b16 v[80:81], v11 offset:20480
  ds_read_b64_tr_b16 v[82:83], v11 offset:20736
  v_mfma_f32_32x32x16_bf16 v[48:63], v[84:87], v[68:71], v[48:63]
  s_waitcnt lgkmcnt(0)
  v_mfma_f32_32x32x16_bf16 v[32:47], v[72:75], v[64:67], v[32:47]
  ds_read_b128 v[68:71], v8 offset:0
  ds_read_b64_tr_b16 v[76:77], v12 offset:16384
  ds_read_b64_tr_b16 v[78:79], v12 offset:16640
  ds_read_b64_tr_b16 v[84:85], v12 offset:20480
  ds_read_b64_tr_b16 v[86:87], v12 offset:20736
  v_mfma_f32_32x32x16_bf16 v[48:63], v[80:83], v[64:67], v[48:63]
  v_mfma_f32_16x16x32_bf16 v[88:91], v[72:75], v[16:19], v[88:91]
  s_waitcnt lgkmcnt(0)
  v_mfma_f32_32x32x16_bf16 v[32:47], v[76:79], v[68:71], v[32:47]
  ds_read_b128 v[64:67], v9 offset:0
  ds_read_b64_tr_b16 v[72:73], v13 offset:16384
  ds_read_b64_tr_b16 v[74:75], v13 offset:16640
  ds_read_b64_tr_b16 v[80:81], v13 offset:20480
  ds_read_b64_tr_b16 v[82:83], v13 offset:20736
  v_mfma_f32_32x32x16_bf16 v[48:63], v[84:87], v[68:71], v[48:63]
  v_mfma_f32_16x16x32_bf16 v[92:95], v[84:87], v[16:19], v[92:95]
  s_waitcnt lgkmcnt(0)
  v_mfma_f32_32x32x16_bf16 v[32:47], v[72:75], v[64:67], v[32:47]
  ds_read_b128 v[68:71], v10 offset:0
  ds_read_b64_tr_b16 v[76:77], v14 offset:16384
  ds_read_b64_tr_b16 v[78:79], v14 offset:16640
  ds_read_b64_tr_b16 v[84:85], v14 offset:20480
  ds_read_b64_tr_b16 v[86:87], v14 offset:20736
  v_mfma_f32_32x32x16_bf16 v[48:63], v[80:83], v[64:67], v[48:63]
  s_waitcnt lgkmcnt(0)
  v_mfma_f32_32x32x16_bf16 v[32:47], v[76:79], v[68:71], v[32:47]
  v_mfma_f32_32x32x16_bf16 v[48:63], v[84:87], v[68:71], v[48:63]
  s_mov_b32 exec_lo, 0x00030003
  s_mov_b32 exec_hi, 0x00030003
  ds_write_b128 v99, v[88:91]
  ds_write_b128 v99, v[92:95] offset:128
  s_mov_b64 exec, -1
  v_mov_b32 v96, 156800
  s_waitcnt lgkmcnt(0)
  s_barrier
  ds_read_b32 v64, v97 offset:0
  ds_read_b32 v68, v97 offset:128
  ds_read_b32 v65, v97 offset:256
  ds_read_b32 v69, v97 offset:384
  ds_read_b32 v66, v97 offset:512
  ds_read_b32 v70, v97 offset:640
  ds_read_b32 v67, v97 offset:768
  ds_read_b32 v71, v97 offset:896
  ds_read_b32 v74, v98
  ds_read_b32 v76, v98 offset:1024
  ds_read_b32 v72, v96
  s_waitcnt lgkmcnt(3)
  v_add_f32 v64, v64, v65
  v_add_f32 v66, v66, v67
  v_add_f32 v64, v64, v66
  v_add_f32 v68, v68, v69
  v_add_f32 v70, v70, v71
  v_add_f32 v68, v68, v70
  ds_write_b32 v100, v64 offset:1024
  ds_write_b32 v100, v68 offset:1152
  s_waitcnt lgkmcnt(0)
  ds_read_b128 v[120:123], v101 offset:128
  ds_read_b128 v[124:127], v101 offset:160
  ds_read_b128 v[128:131], v101 offset:192
  ds_read_b128 v[132:135], v101 offset:224
  ds_read_b128 v[104:107], v101 offset:0
  ds_read_b128 v[108:111], v101 offset:32
  ds_read_b128 v[112:115], v101 offset:64
  ds_read_b128 v[116:119], v101 offset:96
  v_readfirstlane_b32 s39, v72
  v_mul_f32 v78, 0x3eb8aa3b, v74
  s_waitcnt lgkmcnt(4)
  v_pk_fma_f32 v[48:49], v[76:77], v[120:121], v[48:49] op_sel_hi:[0,1,1]
  v_pk_fma_f32 v[50:51], v[76:77], v[122:123], v[50:51] op_sel_hi:[0,1,1]
  v_pk_fma_f32 v[52:53], v[76:77], v[124:125], v[52:53] op_sel_hi:[0,1,1]
  v_pk_fma_f32 v[54:55], v[76:77], v[126:127], v[54:55] op_sel_hi:[0,1,1]
  v_pk_fma_f32 v[56:57], v[76:77], v[128:129], v[56:57] op_sel_hi:[0,1,1]
  v_pk_fma_f32 v[58:59], v[76:77], v[130:131], v[58:59] op_sel_hi:[0,1,1]
  v_pk_fma_f32 v[60:61], v[76:77], v[132:133], v[60:61] op_sel_hi:[0,1,1]
  v_pk_fma_f32 v[62:63], v[76:77], v[134:135], v[62:63] op_sel_hi:[0,1,1]
  v_pk_mul_f32 v[48:49], v[48:49], v[74:75] op_sel_hi:[1,0]
  v_pk_mul_f32 v[50:51], v[50:51], v[74:75] op_sel_hi:[1,0]
  v_pk_mul_f32 v[52:53], v[52:53], v[74:75] op_sel_hi:[1,0]
  v_pk_mul_f32 v[54:55], v[54:55], v[74:75] op_sel_hi:[1,0]
  v_pk_mul_f32 v[56:57], v[56:57], v[74:75] op_sel_hi:[1,0]
  v_pk_mul_f32 v[58:59], v[58:59], v[74:75] op_sel_hi:[1,0]
  v_pk_mul_f32 v[60:61], v[60:61], v[74:75] op_sel_hi:[1,0]
  v_pk_mul_f32 v[62:63], v[62:63], v[74:75] op_sel_hi:[1,0]
  v_cvt_pk_bf16_f32 v80, v48, v49
  v_cvt_pk_bf16_f32 v81, v50, v51
  v_cvt_pk_bf16_f32 v82, v52, v53
  v_cvt_pk_bf16_f32 v83, v54, v55
  v_cvt_pk_bf16_f32 v84, v56, v57
  v_cvt_pk_bf16_f32 v85, v58, v59
  v_cvt_pk_bf16_f32 v86, v60, v61
  v_cvt_pk_bf16_f32 v87, v62, v63
  s_cmp_eq_u32 s39, 0
  s_cbranch_scc1 L_st_slow_1
  buffer_store_dwordx4 v[80:83], v2, s[28:31], s62 offen
  buffer_store_dwordx4 v[84:87], v2, s[28:31], s63 offen
  s_branch L_st_done_2
L_st_slow_1:
  buffer_store_dwordx4 v[80:83], v2, s[28:31], s62 offen sc1
  buffer_store_dwordx4 v[84:87], v2, s[28:31], s63 offen sc1
L_st_done_2:
  ds_write_b128 v102, v[80:83]
  ds_write_b128 v102, v[84:87] offset:8192
  s_waitcnt lgkmcnt(2)
  v_pk_fma_f32 v[32:33], v[76:77], v[104:105], v[32:33] op_sel_hi:[0,1,1]
  v_pk_fma_f32 v[34:35], v[76:77], v[106:107], v[34:35] op_sel_hi:[0,1,1]
  v_pk_fma_f32 v[36:37], v[76:77], v[108:109], v[36:37] op_sel_hi:[0,1,1]
  v_pk_fma_f32 v[38:39], v[76:77], v[110:111], v[38:39] op_sel_hi:[0,1,1]
  v_pk_fma_f32 v[40:41], v[76:77], v[112:113], v[40:41] op_sel_hi:[0,1,1]
  v_pk_fma_f32 v[42:43], v[76:77], v[114:115], v[42:43] op_sel_hi:[0,1,1]
  v_pk_fma_f32 v[44:45], v[76:77], v[116:117], v[44:45] op_sel_hi:[0,1,1]
  v_pk_fma_f32 v[46:47], v[76:77], v[118:119], v[46:47] op_sel_hi:[0,1,1]
  v_pk_mul_f32 v[32:33], v[32:33], v[78:79] op_sel_hi:[1,0]
  v_pk_mul_f32 v[34:35], v[34:35], v[78:79] op_sel_hi:[1,0]
  v_pk_mul_f32 v[36:37], v[36:37], v[78:79] op_sel_hi:[1,0]
  v_pk_mul_f32 v[38:39], v[38:39], v[78:79] op_sel_hi:[1,0]
  v_pk_mul_f32 v[40:41], v[40:41], v[78:79] op_sel_hi:[1,0]
  v_pk_mul_f32 v[42:43], v[42:43], v[78:79] op_sel_hi:[1,0]
  v_pk_mul_f32 v[44:45], v[44:45], v[78:79] op_sel_hi:[1,0]
  v_pk_mul_f32 v[46:47], v[46:47], v[78:79] op_sel_hi:[1,0]
  v_cvt_pk_bf16_f32 v136, v40, v41
  v_cvt_pk_bf16_f32 v137, v42, v43
  v_cvt_pk_bf16_f32 v138, v44, v45
  v_cvt_pk_bf16_f32 v139, v46, v47
  v_cvt_pk_bf16_f32 v28, v32, v33
  v_cvt_pk_bf16_f32 v29, v34, v35
  v_cvt_pk_bf16_f32 v30, v36, v37
  v_cvt_pk_bf16_f32 v31, v38, v39
  v_add_u32 v97, 148992, v102
  ds_write_b128 v97, v[136:139]
  s_waitcnt vmcnt(0) lgkmcnt(0)
  s_barrier
  s_branch L_p1_join
L_p1_roleB:
  v_and_b32 v70, 31, v1
  s_and_b32 s44, s36, 3
  s_lshl_b32 s44, s44, 7
  s_add_u32 s44, s44, 143360
  v_lshlrev_b32 v70, 2, v70
  v_add_u32 v70, s44, v70
  v_and_b32 v71, 1, v1
  v_lshlrev_b32 v71, 6, v71
  v_lshrrev_b32 v68, 4, v1
  v_lshl_add_u32 v71, v68, 4, v71
  s_and_b32 s44, s36, 3
  s_lshl_b32 s44, s44, 7
  s_add_u32 s44, s44, 147456
  v_add_u32 v71, s44, v71
  v_and_b32 v69, 31, v1
  v_lshlrev_b32 v69, 2, v69
  v_add_u32 v69, 147456, v69
  s_and_b32 s44, s36, 3
  s_lshl_b32 s44, s44, 7
  s_add_u32 s44, s44, 143360
  v_lshrrev_b32 v72, 5, v1
  v_lshlrev_b32 v72, 4, v72
  v_add_u32 v72, s44, v72
  v_bfe_u32 v68, v1, 4, 1
  v_lshlrev_b32 v74, 13, v68
  v_lshlrev_b32 v68, 16, v68
  v_lshrrev_b32 v73, 5, v1
  v_lshlrev_b32 v73, 8, v73
  v_and_b32 v4, 15, v1
  v_lshl_add_u32 v73, v4, 4, v73
  v_add_u32 v74, v74, v73
  v_add_u32 v73, v73, v68
  s_lshl_b32 s62, s37, 17
  s_lshl_b32 s45, s38, 12
  s_add_u32 s62, s62, s45
  s_and_b32 s45, s36, 3
  s_lshl_b32 s45, s45, 10
  s_add_u32 s62, s62, s45
  s_add_u32 s62, s62, 2359296
  s_add_u32 s45, s45, 4096
  v_add_u32 v74, s45, v74
  s_setprio 1
  s_barrier
  ds_read_b128 v[48:51], v7 offset:0
  ds_read_b64_tr_b16 v[56:57], v11 offset:24576
  ds_read_b64_tr_b16 v[58:59], v11 offset:24832
  s_waitcnt lgkmcnt(0)
  v_mfma_f32_32x32x16_bf16 v[32:47], v[48:51], v[56:59], 0
  ds_read_b128 v[52:55], v8 offset:0
  ds_read_b64_tr_b16 v[60:61], v12 offset:24576
  ds_read_b64_tr_b16 v[62:63], v12 offset:24832
  v_lshlrev_b32 v20, 16, v48
  v_and_b32 v21, v15, v48
  v_add_f32 v24, v24, v20
  v_add_f32 v25, v25, v21
  v_fmac_f32 v26, v20, v20
  v_fmac_f32 v27, v21, v21
  v_lshlrev_b32 v22, 16, v49
  v_and_b32 v23, v15, v49
  v_add_f32 v24, v24, v22
  v_add_f32 v25, v25, v23
  v_fmac_f32 v26, v22, v22
  v_fmac_f32 v27, v23, v23
  v_lshlrev_b32 v20, 16, v50
  v_and_b32 v21, v15, v50
  v_add_f32 v24, v24, v20
  v_add_f32 v25, v25, v21
  v_fmac_f32 v26, v20, v20
  v_fmac_f32 v27, v21, v21
  v_lshlrev_b32 v22, 16, v51
  v_and_b32 v23, v15, v51
  v_add_f32 v24, v24, v22
  v_add_f32 v25, v25, v23
  v_fmac_f32 v26, v22, v22
  v_fmac_f32 v27, v23, v23
  v_mfma_f32_16x16x32_bf16 v[64:67], v[56:59], v[16:19], 0
  s_waitcnt lgkmcnt(0)
  v_mfma_f32_32x32x16_bf16 v[32:47], v[52:55], v[60:63], v[32:47]
  ds_read_b128 v[48:51], v9 offset:0
  ds_read_b64_tr_b16 v[56:57], v13 offset:24576
  ds_read_b64_tr_b16 v[58:59], v13 offset:24832
  v_lshlrev_b32 v20, 16, v52
  v_and_b32 v21, v15, v52
  v_add_f32 v24, v24, v20
  v_add_f32 v25, v25, v21
  v_fmac_f32 v26, v20, v20
  v_fmac_f32 v27, v21, v21
  v_lshlrev_b32 v22, 16, v53
  v_and_b32 v23, v15, v53
  v_add_f32 v24, v24, v22
  v_add_f32 v25, v25, v23
  v_fmac_f32 v26, v22, v22
  v_fmac_f32 v27, v23, v23
  v_lshlrev_b32 v20, 16, v54
  v_and_b32 v21, v15, v54
  v_add_f32 v24, v24, v20
  v_add_f32 v25, v25, v21
  v_fmac_f32 v26, v20, v20
  v_fmac_f32 v27, v21, v21
  v_lshlrev_b32 v22, 16, v55
  v_and_b32 v23, v15, v55
  v_add_f32 v24, v24, v22
  v_add_f32 v25, v25, v23
  v_fmac_f32 v26, v22, v22
  v_fmac_f32 v27, v23, v23
  s_waitcnt lgkmcnt(0)
  v_mfma_f32_32x32x16_bf16 v[32:47], v[48:51], v[56:59], v[32:47]
  ds_read_b128 v[52:55], v10 offset:0
  ds_read_b64_tr_b16 v[60:61], v14 offset:24576
  ds_read_b64_tr_b16 v[62:63], v14 offset:24832
  v_lshlrev_b32 v20, 16, v48
  v_and_b32 v21, v15, v48
  v_add_f32 v24, v24, v20
  v_add_f32 v25, v25, v21
  v_fmac_f32 v26, v20, v20
  v_fmac_f32 v27, v21, v21
  v_lshlrev_b32 v22, 16, v49
  v_and_b32 v23, v15, v49
  v_add_f32 v24, v24, v22
  v_add_f32 v25, v25, v23
  v_fmac_f32 v26, v22, v22
  v_fmac_f32 v27, v23, v23
  v_lshlrev_b32 v20, 16, v50
  v_and_b32 v21, v15, v50
  v_add_f32 v24, v24, v20
  v_add_f32 v25, v25, v21
  v_fmac_f32 v26, v20, v20
  v_fmac_f32 v27, v21, v21
  v_lshlrev_b32 v22, 16, v51
  v_and_b32 v23, v15, v51
  v_add_f32 v24, v24, v22
  v_add_f32 v25, v25, v23
  v_fmac_f32 v26, v22, v22
  v_fmac_f32 v27, v23, v23
  s_waitcnt lgkmcnt(0)
  s_barrier
  v_mfma_f32_32x32x16_bf16 v[32:47], v[52:55], v[60:63], v[32:47]
  ds_read_b128 v[48:51], v7 offset:28672
  ds_read_b64_tr_b16 v[56:57], v11 offset:53248
  ds_read_b64_tr_b16 v[58:59], v11 offset:53504
  v_lshlrev_b32 v20, 16, v52
  v_and_b32 v21, v15, v52
  v_add_f32 v24, v24, v20
  v_add_f32 v25, v25, v21
  v_fmac_f32 v26, v20, v20
  v_fmac_f32 v27, v21, v21
  v_lshlrev_b32 v22, 16, v53
  v_and_b32 v23, v15, v53
  v_add_f32 v24, v24, v22
  v_add_f32 v25, v25, v23
  v_fmac_f32 v26, v22, v22
  v_fmac_f32 v27, v23, v23
  v_lshlrev_b32 v20, 16, v54
  v_and_b32 v21, v15, v54
  v_add_f32 v24, v24, v20
  v_add_f32 v25, v25, v21
  v_fmac_f32 v26, v20, v20
  v_fmac_f32 v27, v21, v21
  v_lshlrev_b32 v22, 16, v55
  v_and_b32 v23, v15, v55
  v_add_f32 v24, v24, v22
  v_add_f32 v25, v25, v23
  v_fmac_f32 v26, v22, v22
  v_fmac_f32 v27, v23, v23
  s_waitcnt lgkmcnt(0)
  v_mfma_f32_32x32x16_bf16 v[32:47], v[48:51], v[56:59], v[32:47]
  ds_read_b128 v[52:55], v8 offset:28672
  ds_read_b64_tr_b16 v[60:61], v12 offset:53248
  ds_read_b64_tr_b16 v[62:63], v12 offset:53504
  v_lshlrev_b32 v20, 16, v48
  v_and_b32 v21, v15, v48
  v_add_f32 v24, v24, v20
  v_add_f32 v25, v25, v21
  v_fmac_f32 v26, v20, v20
  v_fmac_f32 v27, v21, v21
  v_lshlrev_b32 v22, 16, v49
  v_and_b32 v23, v15, v49
  v_add_f32 v24, v24, v22
  v_add_f32 v25, v25, v23
  v_fmac_f32 v26, v22, v22
  v_fmac_f32 v27, v23, v23
  v_lshlrev_b32 v20, 16, v50
  v_and_b32 v21, v15, v50
  v_add_f32 v24, v24, v20
  v_add_f32 v25, v25, v21
  v_fmac_f32 v26, v20, v20
  v_fmac_f32 v27, v21, v21
  v_lshlrev_b32 v22, 16, v51
  v_and_b32 v23, v15, v51
  v_add_f32 v24, v24, v22
  v_add_f32 v25, v25, v23
  v_fmac_f32 v26, v22, v22
  v_fmac_f32 v27, v23, v23
  v_mfma_f32_16x16x32_bf16 v[64:67], v[56:59], v[16:19], v[64:67]
  s_waitcnt lgkmcnt(0)
  v_mfma_f32_32x32x16_bf16 v[32:47], v[52:55], v[60:63], v[32:47]
  ds_read_b128 v[48:51], v9 offset:28672
  ds_read_b64_tr_b16 v[56:57], v13 offset:53248
  ds_read_b64_tr_b16 v[58:59], v13 offset:53504
  v_lshlrev_b32 v20, 16, v52
  v_and_b32 v21, v15, v52
  v_add_f32 v24, v24, v20
  v_add_f32 v25, v25, v21
  v_fmac_f32 v26, v20, v20
  v_fmac_f32 v27, v21, v21
  v_lshlrev_b32 v22, 16, v53
  v_and_b32 v23, v15, v53
  v_add_f32 v24, v24, v22
  v_add_f32 v25, v25, v23
  v_fmac_f32 v26, v22, v22
  v_fmac_f32 v27, v23, v23
  v_lshlrev_b32 v20, 16, v54
  v_and_b32 v21, v15, v54
  v_add_f32 v24, v24, v20
  v_add_f32 v25, v25, v21
  v_fmac_f32 v26, v20, v20
  v_fmac_f32 v27, v21, v21
  v_lshlrev_b32 v22, 16, v55
  v_and_b32 v23, v15, v55
  v_add_f32 v24, v24, v22
  v_add_f32 v25, v25, v23
  v_fmac_f32 v26, v22, v22
  v_fmac_f32 v27, v23, v23
  s_waitcnt lgkmcnt(0)
  v_mfma_f32_32x32x16_bf16 v[32:47], v[48:51], v[56:59], v[32:47]
  ds_read_b128 v[52:55], v10 offset:28672
  ds_read_b64_tr_b16 v[60:61], v14 offset:53248
  ds_read_b64_tr_b16 v[62:63], v14 offset:53504
  v_lshlrev_b32 v20, 16, v48
  v_and_b32 v21, v15, v48
  v_add_f32 v24, v24, v20
  v_add_f32 v25, v25, v21
  v_fmac_f32 v26, v20, v20
  v_fmac_f32 v27, v21, v21
  v_lshlrev_b32 v22, 16, v49
  v_and_b32 v23, v15, v49
  v_add_f32 v24, v24, v22
  v_add_f32 v25, v25, v23
  v_fmac_f32 v26, v22, v22
  v_fmac_f32 v27, v23, v23
  v_lshlrev_b32 v20, 16, v50
  v_and_b32 v21, v15, v50
  v_add_f32 v24, v24, v20
  v_add_f32 v25, v25, v21
  v_fmac_f32 v26, v20, v20
  v_fmac_f32 v27, v21, v21
  v_lshlrev_b32 v22, 16, v51
  v_and_b32 v23, v15, v51
  v_add_f32 v24, v24, v22
  v_add_f32 v25, v25, v23
  v_fmac_f32 v26, v22, v22
  v_fmac_f32 v27, v23, v23
  s_waitcnt lgkmcnt(0)
  v_add_u32 v7, 57344, v7
  v_add_u32 v8, 57344, v8
  v_add_u32 v9, 57344, v9
  v_add_u32 v10, 57344, v10
  v_add_u32 v11, 57344, v11
  v_add_u32 v12, 57344, v12
  v_add_u32 v13, 57344, v13
  v_add_u32 v14, 57344, v14
  s_barrier
  v_mfma_f32_32x32x16_bf16 v[32:47], v[52:55], v[60:63], v[32:47]
  ds_read_b128 v[48:51], v7 offset:0
  ds_read_b64_tr_b16 v[56:57], v11 offset:24576
  ds_read_b64_tr_b16 v[58:59], v11 offset:24832
  v_lshlrev_b32 v20, 16, v52
  v_and_b32 v21, v15, v52
  v_add_f32 v24, v24, v20
  v_add_f32 v25, v25, v21
  v_fmac_f32 v26, v20, v20
  v_fmac_f32 v27, v21, v21
  v_lshlrev_b32 v22, 16, v53
  v_and_b32 v23, v15, v53
  v_add_f32 v24, v24, v22
  v_add_f32 v25, v25, v23
  v_fmac_f32 v26, v22, v22
  v_fmac_f32 v27, v23, v23
  v_lshlrev_b32 v20, 16, v54
  v_and_b32 v21, v15, v54
  v_add_f32 v24, v24, v20
  v_add_f32 v25, v25, v21
  v_fmac_f32 v26, v20, v20
  v_fmac_f32 v27, v21, v21
  v_lshlrev_b32 v22, 16, v55
  v_and_b32 v23, v15, v55
  v_add_f32 v24, v24, v22
  v_add_f32 v25, v25, v23
  v_fmac_f32 v26, v22, v22
  v_fmac_f32 v27, v23, v23
  s_waitcnt lgkmcnt(0)
  v_mfma_f32_32x32x16_bf16 v[32:47], v[48:51], v[56:59], v[32:47]
  ds_read_b128 v[52:55], v8 offset:0
  ds_read_b64_tr_b16 v[60:61], v12 offset:24576
  ds_read_b64_tr_b16 v[62:63], v12 offset:24832
  v_lshlrev_b32 v20, 16, v48
  v_and_b32 v21, v15, v48
  v_add_f32 v24, v24, v20
  v_add_f32 v25, v25, v21
  v_fmac_f32 v26, v20, v20
  v_fmac_f32 v27, v21, v21
  v_lshlrev_b32 v22, 16, v49
  v_and_b32 v23, v15, v49
  v_add_f32 v24, v24, v22
  v_add_f32 v25, v25, v23
  v_fmac_f32 v26, v22, v22
  v_fmac_f32 v27, v23, v23
  v_lshlrev_b32 v20, 16, v50
  v_and_b32 v21, v15, v50
  v_add_f32 v24, v24, v20
  v_add_f32 v25, v25, v21
  v_fmac_f32 v26, v20, v20
  v_fmac_f32 v27, v21, v21
  v_lshlrev_b32 v22, 16, v51
  v_and_b32 v23, v15, v51
  v_add_f32 v24, v24, v22
  v_add_f32 v25, v25, v23
  v_fmac_f32 v26, v22, v22
  v_fmac_f32 v27, v23, v23
  v_mfma_f32_16x16x32_bf16 v[64:67], v[56:59], v[16:19], v[64:67]
  s_waitcnt lgkmcnt(0)
  v_mfma_f32_32x32x16_bf16 v[32:47], v[52:55], v[60:63], v[32:47]
  ds_read_b128 v[48:51], v9 offset:0
  ds_read_b64_tr_b16 v[56:57], v13 offset:24576
  ds_read_b64_tr_b16 v[58:59], v13 offset:24832
  v_lshlrev_b32 v20, 16, v52
  v_and_b32 v21, v15, v52
  v_add_f32 v24, v24, v20
  v_add_f32 v25, v25, v21
  v_fmac_f32 v26, v20, v20
  v_fmac_f32 v27, v21, v21
  v_lshlrev_b32 v22, 16, v53
  v_and_b32 v23, v15, v53
  v_add_f32 v24, v24, v22
  v_add_f32 v25, v25, v23
  v_fmac_f32 v26, v22, v22
  v_fmac_f32 v27, v23, v23
  v_lshlrev_b32 v20, 16, v54
  v_and_b32 v21, v15, v54
  v_add_f32 v24, v24, v20
  v_add_f32 v25, v25, v21
  v_fmac_f32 v26, v20, v20
  v_fmac_f32 v27, v21, v21
  v_lshlrev_b32 v22, 16, v55
  v_and_b32 v23, v15, v55
  v_add_f32 v24, v24, v22
  v_add_f32 v25, v25, v23
  v_fmac_f32 v26, v22, v22
  v_fmac_f32 v27, v23, v23
  s_waitcnt lgkmcnt(0)
  v_mfma_f32_32x32x16_bf16 v[32:47], v[48:51], v[56:59], v[32:47]
  ds_read_b128 v[52:55], v10 offset:0
  ds_read_b64_tr_b16 v[60:61], v14 offset:24576
  ds_read_b64_tr_b16 v[62:63], v14 offset:24832
  v_lshlrev_b32 v20, 16, v48
  v_and_b32 v21, v15, v48
  v_add_f32 v24, v24, v20
  v_add_f32 v25, v25, v21
  v_fmac_f32 v26, v20, v20
  v_fmac_f32 v27, v21, v21
  v_lshlrev_b32 v22, 16, v49
  v_and_b32 v23, v15, v49
  v_add_f32 v24, v24, v22
  v_add_f32 v25, v25, v23
  v_fmac_f32 v26, v22, v22
  v_fmac_f32 v27, v23, v23
  v_lshlrev_b32 v20, 16, v50
  v_and_b32 v21, v15, v50
  v_add_f32 v24, v24, v20
  v_add_f32 v25, v25, v21
  v_fmac_f32 v26, v20, v20
  v_fmac_f32 v27, v21, v21
  v_lshlrev_b32 v22, 16, v51
  v_and_b32 v23, v15, v51
  v_add_f32 v24, v24, v22
  v_add_f32 v25, v25, v23
  v_fmac_f32 v26, v22, v22
  v_fmac_f32 v27, v23, v23
  s_waitcnt lgkmcnt(0)
  s_barrier
  v_mfma_f32_32x32x16_bf16 v[32:47], v[52:55], v[60:63], v[32:47]
  ds_read_b128 v[48:51], v7 offset:28672
  ds_read_b64_tr_b16 v[56:57], v11 offset:53248
  ds_read_b64_tr_b16 v[58:59], v11 offset:53504
  v_lshlrev_b32 v20, 16, v52
  v_and_b32 v21, v15, v52
  v_add_f32 v24, v24, v20
  v_add_f32 v25, v25, v21
  v_fmac_f32 v26, v20, v20
  v_fmac_f32 v27, v21, v21
  v_lshlrev_b32 v22, 16, v53
  v_and_b32 v23, v15, v53
  v_add_f32 v24, v24, v22
  v_add_f32 v25, v25, v23
  v_fmac_f32 v26, v22, v22
  v_fmac_f32 v27, v23, v23
  v_lshlrev_b32 v20, 16, v54
  v_and_b32 v21, v15, v54
  v_add_f32 v24, v24, v20
  v_add_f32 v25, v25, v21
  v_fmac_f32 v26, v20, v20
  v_fmac_f32 v27, v21, v21
  v_lshlrev_b32 v22, 16, v55
  v_and_b32 v23, v15, v55
  v_add_f32 v24, v24, v22
  v_add_f32 v25, v25, v23
  v_fmac_f32 v26, v22, v22
  v_fmac_f32 v27, v23, v23
  s_waitcnt lgkmcnt(0)
  v_mfma_f32_32x32x16_bf16 v[32:47], v[48:51], v[56:59], v[32:47]
  ds_read_b128 v[52:55], v8 offset:28672
  ds_read_b64_tr_b16 v[60:61], v12 offset:53248
  ds_read_b64_tr_b16 v[62:63], v12 offset:53504
  v_lshlrev_b32 v20, 16, v48
  v_and_b32 v21, v15, v48
  v_add_f32 v24, v24, v20
  v_add_f32 v25, v25, v21
  v_fmac_f32 v26, v20, v20
  v_fmac_f32 v27, v21, v21
  v_lshlrev_b32 v22, 16, v49
  v_and_b32 v23, v15, v49
  v_add_f32 v24, v24, v22
  v_add_f32 v25, v25, v23
  v_fmac_f32 v26, v22, v22
  v_fmac_f32 v27, v23, v23
  v_lshlrev_b32 v20, 16, v50
  v_and_b32 v21, v15, v50
  v_add_f32 v24, v24, v20
  v_add_f32 v25, v25, v21
  v_fmac_f32 v26, v20, v20
  v_fmac_f32 v27, v21, v21
  v_lshlrev_b32 v22, 16, v51
  v_and_b32 v23, v15, v51
  v_add_f32 v24, v24, v22
  v_add_f32 v25, v25, v23
  v_fmac_f32 v26, v22, v22
  v_fmac_f32 v27, v23, v23
  v_mfma_f32_16x16x32_bf16 v[64:67], v[56:59], v[16:19], v[64:67]
  s_waitcnt lgkmcnt(0)
  v_mfma_f32_32x32x16_bf16 v[32:47], v[52:55], v[60:63], v[32:47]
  ds_read_b128 v[48:51], v9 offset:28672
  ds_read_b64_tr_b16 v[56:57], v13 offset:53248
  ds_read_b64_tr_b16 v[58:59], v13 offset:53504
  v_lshlrev_b32 v20, 16, v52
  v_and_b32 v21, v15, v52
  v_add_f32 v24, v24, v20
  v_add_f32 v25, v25, v21
  v_fmac_f32 v26, v20, v20
  v_fmac_f32 v27, v21, v21
  v_lshlrev_b32 v22, 16, v53
  v_and_b32 v23, v15, v53
  v_add_f32 v24, v24, v22
  v_add_f32 v25, v25, v23
  v_fmac_f32 v26, v22, v22
  v_fmac_f32 v27, v23, v23
  v_lshlrev_b32 v20, 16, v54
  v_and_b32 v21, v15, v54
  v_add_f32 v24, v24, v20
  v_add_f32 v25, v25, v21
  v_fmac_f32 v26, v20, v20
  v_fmac_f32 v27, v21, v21
  v_lshlrev_b32 v22, 16, v55
  v_and_b32 v23, v15, v55
  v_add_f32 v24, v24, v22
  v_add_f32 v25, v25, v23
  v_fmac_f32 v26, v22, v22
  v_fmac_f32 v27, v23, v23
  s_waitcnt lgkmcnt(0)
  v_mfma_f32_32x32x16_bf16 v[32:47], v[48:51], v[56:59], v[32:47]
  ds_read_b128 v[52:55], v10 offset:28672
  ds_read_b64_tr_b16 v[60:61], v14 offset:53248
  ds_read_b64_tr_b16 v[62:63], v14 offset:53504
  v_lshlrev_b32 v20, 16, v48
  v_and_b32 v21, v15, v48
  v_add_f32 v24, v24, v20
  v_add_f32 v25, v25, v21
  v_fmac_f32 v26, v20, v20
  v_fmac_f32 v27, v21, v21
  v_lshlrev_b32 v22, 16, v49
  v_and_b32 v23, v15, v49
  v_add_f32 v24, v24, v22
  v_add_f32 v25, v25, v23
  v_fmac_f32 v26, v22, v22
  v_fmac_f32 v27, v23, v23
  v_lshlrev_b32 v20, 16, v50
  v_and_b32 v21, v15, v50
  v_add_f32 v24, v24, v20
  v_add_f32 v25, v25, v21
  v_fmac_f32 v26, v20, v20
  v_fmac_f32 v27, v21, v21
  v_lshlrev_b32 v22, 16, v51
  v_and_b32 v23, v15, v51
  v_add_f32 v24, v24, v22
  v_add_f32 v25, v25, v23
  v_fmac_f32 v26, v22, v22
  v_fmac_f32 v27, v23, v23
  s_waitcnt lgkmcnt(0)
  v_add_u32 v7, 57344, v7
  v_add_u32 v8, 57344, v8
  v_add_u32 v9, 57344, v9
  v_add_u32 v10, 57344, v10
  v_add_u32 v11, 57344, v11
  v_add_u32 v12, 57344, v12
  v_add_u32 v13, 57344, v13
  v_add_u32 v14, 57344, v14
  s_barrier
  v_mfma_f32_32x32x16_bf16 v[32:47], v[52:55], v[60:63], v[32:47]
  ds_read_b128 v[48:51], v7 offset:0
  ds_read_b64_tr_b16 v[56:57], v11 offset:24576
  ds_read_b64_tr_b16 v[58:59], v11 offset:24832
  v_lshlrev_b32 v20, 16, v52
  v_and_b32 v21, v15, v52
  v_add_f32 v24, v24, v20
  v_add_f32 v25, v25, v21
  v_fmac_f32 v26, v20, v20
  v_fmac_f32 v27, v21, v21
  v_lshlrev_b32 v22, 16, v53
  v_and_b32 v23, v15, v53
  v_add_f32 v24, v24, v22
  v_add_f32 v25, v25, v23
  v_fmac_f32 v26, v22, v22
  v_fmac_f32 v27, v23, v23
  v_lshlrev_b32 v20, 16, v54
  v_and_b32 v21, v15, v54
  v_add_f32 v24, v24, v20
  v_add_f32 v25, v25, v21
  v_fmac_f32 v26, v20, v20
  v_fmac_f32 v27, v21, v21
  v_lshlrev_b32 v22, 16, v55
  v_and_b32 v23, v15, v55
  v_add_f32 v24, v24, v22
  v_add_f32 v25, v25, v23
  v_fmac_f32 v26, v22, v22
  v_fmac_f32 v27, v23, v23
  s_waitcnt lgkmcnt(0)
  v_mfma_f32_32x32x16_bf16 v[32:47], v[48:51], v[56:59], v[32:47]
  ds_read_b128 v[52:55], v8 offset:0
  ds_read_b64_tr_b16 v[60:61], v12 offset:24576
  ds_read_b64_tr_b16 v[62:63], v12 offset:24832
  v_lshlrev_b32 v20, 16, v48
  v_and_b32 v21, v15, v48
  v_add_f32 v24, v24, v20
  v_add_f32 v25, v25, v21
  v_fmac_f32 v26, v20, v20
  v_fmac_f32 v27, v21, v21
  v_lshlrev_b32 v22, 16, v49
  v_and_b32 v23, v15, v49
  v_add_f32 v24, v24, v22
  v_add_f32 v25, v25, v23
  v_fmac_f32 v26, v22, v22
  v_fmac_f32 v27, v23, v23
  v_lshlrev_b32 v20, 16, v50
  v_and_b32 v21, v15, v50
  v_add_f32 v24, v24, v20
  v_add_f32 v25, v25, v21
  v_fmac_f32 v26, v20, v20
  v_fmac_f32 v27, v21, v21
  v_lshlrev_b32 v22, 16, v51
  v_and_b32 v23, v15, v51
  v_add_f32 v24, v24, v22
  v_add_f32 v25, v25, v23
  v_fmac_f32 v26, v22, v22
  v_fmac_f32 v27, v23, v23
  v_mfma_f32_16x16x32_bf16 v[64:67], v[56:59], v[16:19], v[64:67]
  s_waitcnt lgkmcnt(0)
  v_mfma_f32_32x32x16_bf16 v[32:47], v[52:55], v[60:63], v[32:47]
  ds_read_b128 v[48:51], v9 offset:0
  ds_read_b64_tr_b16 v[56:57], v13 offset:24576
  ds_read_b64_tr_b16 v[58:59], v13 offset:24832
  v_lshlrev_b32 v20, 16, v52
  v_and_b32 v21, v15, v52
  v_add_f32 v24, v24, v20
  v_add_f32 v25, v25, v21
  v_fmac_f32 v26, v20, v20
  v_fmac_f32 v27, v21, v21
  v_lshlrev_b32 v22, 16, v53
  v_and_b32 v23, v15, v53
  v_add_f32 v24, v24, v22
  v_add_f32 v25, v25, v23
  v_fmac_f32 v26, v22, v22
  v_fmac_f32 v27, v23, v23
  v_lshlrev_b32 v20, 16, v54
  v_and_b32 v21, v15, v54
  v_add_f32 v24, v24, v20
  v_add_f32 v25, v25, v21
  v_fmac_f32 v26, v20, v20
  v_fmac_f32 v27, v21, v21
  v_lshlrev_b32 v22, 16, v55
  v_and_b32 v23, v15, v55
  v_add_f32 v24, v24, v22
  v_add_f32 v25, v25, v23
  v_fmac_f32 v26, v22, v22
  v_fmac_f32 v27, v23, v23
  s_waitcnt lgkmcnt(0)
  v_mfma_f32_32x32x16_bf16 v[32:47], v[48:51], v[56:59], v[32:47]
  ds_read_b128 v[52:55], v10 offset:0
  ds_read_b64_tr_b16 v[60:61], v14 offset:24576
  ds_read_b64_tr_b16 v[62:63], v14 offset:24832
  v_lshlrev_b32 v20, 16, v48
  v_and_b32 v21, v15, v48
  v_add_f32 v24, v24, v20
  v_add_f32 v25, v25, v21
  v_fmac_f32 v26, v20, v20
  v_fmac_f32 v27, v21, v21
  v_lshlrev_b32 v22, 16, v49
  v_and_b32 v23, v15, v49
  v_add_f32 v24, v24, v22
  v_add_f32 v25, v25, v23
  v_fmac_f32 v26, v22, v22
  v_fmac_f32 v27, v23, v23
  v_lshlrev_b32 v20, 16, v50
  v_and_b32 v21, v15, v50
  v_add_f32 v24, v24, v20
  v_add_f32 v25, v25, v21
  v_fmac_f32 v26, v20, v20
  v_fmac_f32 v27, v21, v21
  v_lshlrev_b32 v22, 16, v51
  v_and_b32 v23, v15, v51
  v_add_f32 v24, v24, v22
  v_add_f32 v25, v25, v23
  v_fmac_f32 v26, v22, v22
  v_fmac_f32 v27, v23, v23
  s_waitcnt lgkmcnt(0)
  v_subrev_u32 v7, 114688, v7
  v_subrev_u32 v8, 114688, v8
  v_subrev_u32 v9, 114688, v9
  v_subrev_u32 v10, 114688, v10
  v_subrev_u32 v11, 114688, v11
  v_subrev_u32 v12, 114688, v12
  v_subrev_u32 v13, 114688, v13
  v_subrev_u32 v14, 114688, v14
  s_barrier
  v_mfma_f32_32x32x16_bf16 v[32:47], v[52:55], v[60:63], v[32:47]
  ds_read_b128 v[48:51], v7 offset:0
  ds_read_b64_tr_b16 v[56:57], v11 offset:24576
  ds_read_b64_tr_b16 v[58:59], v11 offset:24832
  v_lshlrev_b32 v20, 16, v52
  v_and_b32 v21, v15, v52
  v_add_f32 v24, v24, v20
  v_add_f32 v25, v25, v21
  v_fmac_f32 v26, v20, v20
  v_fmac_f32 v27, v21, v21
  v_lshlrev_b32 v22, 16, v53
  v_and_b32 v23, v15, v53
  v_add_f32 v24, v24, v22
  v_add_f32 v25, v25, v23
  v_fmac_f32 v26, v22, v22
  v_fmac_f32 v27, v23, v23
  v_lshlrev_b32 v20, 16, v54
  v_and_b32 v21, v15, v54
  v_add_f32 v24, v24, v20
  v_add_f32 v25, v25, v21
  v_fmac_f32 v26, v20, v20
  v_fmac_f32 v27, v21, v21
  v_lshlrev_b32 v22, 16, v55
  v_and_b32 v23, v15, v55
  v_add_f32 v24, v24, v22
  v_add_f32 v25, v25, v23
  v_fmac_f32 v26, v22, v22
  v_fmac_f32 v27, v23, v23
  s_waitcnt lgkmcnt(0)
  v_mfma_f32_32x32x16_bf16 v[32:47], v[48:51], v[56:59], v[32:47]
  ds_read_b128 v[52:55], v8 offset:0
  ds_read_b64_tr_b16 v[60:61], v12 offset:24576
  ds_read_b64_tr_b16 v[62:63], v12 offset:24832
  v_lshlrev_b32 v20, 16, v48
  v_and_b32 v21, v15, v48
  v_add_f32 v24, v24, v20
  v_add_f32 v25, v25, v21
  v_fmac_f32 v26, v20, v20
  v_fmac_f32 v27, v21, v21
  v_lshlrev_b32 v22, 16, v49
  v_and_b32 v23, v15, v49
  v_add_f32 v24, v24, v22
  v_add_f32 v25, v25, v23
  v_fmac_f32 v26, v22, v22
  v_fmac_f32 v27, v23, v23
  v_lshlrev_b32 v20, 16, v50
  v_and_b32 v21, v15, v50
  v_add_f32 v24, v24, v20
  v_add_f32 v25, v25, v21
  v_fmac_f32 v26, v20, v20
  v_fmac_f32 v27, v21, v21
  v_lshlrev_b32 v22, 16, v51
  v_and_b32 v23, v15, v51
  v_add_f32 v24, v24, v22
  v_add_f32 v25, v25, v23
  v_fmac_f32 v26, v22, v22
  v_fmac_f32 v27, v23, v23
  v_mfma_f32_16x16x32_bf16 v[64:67], v[56:59], v[16:19], v[64:67]
  s_waitcnt lgkmcnt(0)
  v_mfma_f32_32x32x16_bf16 v[32:47], v[52:55], v[60:63], v[32:47]
  ds_read_b128 v[48:51], v9 offset:0
  ds_read_b64_tr_b16 v[56:57], v13 offset:24576
  ds_read_b64_tr_b16 v[58:59], v13 offset:24832
  v_lshlrev_b32 v20, 16, v52
  v_and_b32 v21, v15, v52
  v_add_f32 v24, v24, v20
  v_add_f32 v25, v25, v21
  v_fmac_f32 v26, v20, v20
  v_fmac_f32 v27, v21, v21
  v_lshlrev_b32 v22, 16, v53
  v_and_b32 v23, v15, v53
  v_add_f32 v24, v24, v22
  v_add_f32 v25, v25, v23
  v_fmac_f32 v26, v22, v22
  v_fmac_f32 v27, v23, v23
  v_lshlrev_b32 v20, 16, v54
  v_and_b32 v21, v15, v54
  v_add_f32 v24, v24, v20
  v_add_f32 v25, v25, v21
  v_fmac_f32 v26, v20, v20
  v_fmac_f32 v27, v21, v21
  v_lshlrev_b32 v22, 16, v55
  v_and_b32 v23, v15, v55
  v_add_f32 v24, v24, v22
  v_add_f32 v25, v25, v23
  v_fmac_f32 v26, v22, v22
  v_fmac_f32 v27, v23, v23
  s_waitcnt lgkmcnt(0)
  v_mfma_f32_32x32x16_bf16 v[32:47], v[48:51], v[56:59], v[32:47]
  ds_read_b128 v[52:55], v10 offset:0
  ds_read_b64_tr_b16 v[60:61], v14 offset:24576
  ds_read_b64_tr_b16 v[62:63], v14 offset:24832
  v_lshlrev_b32 v20, 16, v48
  v_and_b32 v21, v15, v48
  v_add_f32 v24, v24, v20
  v_add_f32 v25, v25, v21
  v_fmac_f32 v26, v20, v20
  v_fmac_f32 v27, v21, v21
  v_lshlrev_b32 v22, 16, v49
  v_and_b32 v23, v15, v49
  v_add_f32 v24, v24, v22
  v_add_f32 v25, v25, v23
  v_fmac_f32 v26, v22, v22
  v_fmac_f32 v27, v23, v23
  v_lshlrev_b32 v20, 16, v50
  v_and_b32 v21, v15, v50
  v_add_f32 v24, v24, v20
  v_add_f32 v25, v25, v21
  v_fmac_f32 v26, v20, v20
  v_fmac_f32 v27, v21, v21
  v_lshlrev_b32 v22, 16, v51
  v_and_b32 v23, v15, v51
  v_add_f32 v24, v24, v22
  v_add_f32 v25, v25, v23
  v_fmac_f32 v26, v22, v22
  v_fmac_f32 v27, v23, v23
  s_waitcnt lgkmcnt(0)
  s_barrier
  v_mfma_f32_32x32x16_bf16 v[32:47], v[52:55], v[60:63], v[32:47]
  ds_read_b128 v[48:51], v7 offset:28672
  ds_read_b64_tr_b16 v[56:57], v11 offset:53248
  ds_read_b64_tr_b16 v[58:59], v11 offset:53504
  v_lshlrev_b32 v20, 16, v52
  v_and_b32 v21, v15, v52
  v_add_f32 v24, v24, v20
  v_add_f32 v25, v25, v21
  v_fmac_f32 v26, v20, v20
  v_fmac_f32 v27, v21, v21
  v_lshlrev_b32 v22, 16, v53
  v_and_b32 v23, v15, v53
  v_add_f32 v24, v24, v22
  v_add_f32 v25, v25, v23
  v_fmac_f32 v26, v22, v22
  v_fmac_f32 v27, v23, v23
  v_lshlrev_b32 v20, 16, v54
  v_and_b32 v21, v15, v54
  v_add_f32 v24, v24, v20
  v_add_f32 v25, v25, v21
  v_fmac_f32 v26, v20, v20
  v_fmac_f32 v27, v21, v21
  v_lshlrev_b32 v22, 16, v55
  v_and_b32 v23, v15, v55
  v_add_f32 v24, v24, v22
  v_add_f32 v25, v25, v23
  v_fmac_f32 v26, v22, v22
  v_fmac_f32 v27, v23, v23
  s_waitcnt lgkmcnt(0)
  v_mfma_f32_32x32x16_bf16 v[32:47], v[48:51], v[56:59], v[32:47]
  ds_read_b128 v[52:55], v8 offset:28672
  ds_read_b64_tr_b16 v[60:61], v12 offset:53248
  ds_read_b64_tr_b16 v[62:63], v12 offset:53504
  v_lshlrev_b32 v20, 16, v48
  v_and_b32 v21, v15, v48
  v_add_f32 v24, v24, v20
  v_add_f32 v25, v25, v21
  v_fmac_f32 v26, v20, v20
  v_fmac_f32 v27, v21, v21
  v_lshlrev_b32 v22, 16, v49
  v_and_b32 v23, v15, v49
  v_add_f32 v24, v24, v22
  v_add_f32 v25, v25, v23
  v_fmac_f32 v26, v22, v22
  v_fmac_f32 v27, v23, v23
  v_lshlrev_b32 v20, 16, v50
  v_and_b32 v21, v15, v50
  v_add_f32 v24, v24, v20
  v_add_f32 v25, v25, v21
  v_fmac_f32 v26, v20, v20
  v_fmac_f32 v27, v21, v21
  v_lshlrev_b32 v22, 16, v51
  v_and_b32 v23, v15, v51
  v_add_f32 v24, v24, v22
  v_add_f32 v25, v25, v23
  v_fmac_f32 v26, v22, v22
  v_fmac_f32 v27, v23, v23
  v_mfma_f32_16x16x32_bf16 v[64:67], v[56:59], v[16:19], v[64:67]
  s_waitcnt lgkmcnt(0)
  v_mfma_f32_32x32x16_bf16 v[32:47], v[52:55], v[60:63], v[32:47]
  ds_read_b128 v[48:51], v9 offset:28672
  ds_read_b64_tr_b16 v[56:57], v13 offset:53248
  ds_read_b64_tr_b16 v[58:59], v13 offset:53504
  v_lshlrev_b32 v20, 16, v52
  v_and_b32 v21, v15, v52
  v_add_f32 v24, v24, v20
  v_add_f32 v25, v25, v21
  v_fmac_f32 v26, v20, v20
  v_fmac_f32 v27, v21, v21
  v_lshlrev_b32 v22, 16, v53
  v_and_b32 v23, v15, v53
  v_add_f32 v24, v24, v22
  v_add_f32 v25, v25, v23
  v_fmac_f32 v26, v22, v22
  v_fmac_f32 v27, v23, v23
  v_lshlrev_b32 v20, 16, v54
  v_and_b32 v21, v15, v54
  v_add_f32 v24, v24, v20
  v_add_f32 v25, v25, v21
  v_fmac_f32 v26, v20, v20
  v_fmac_f32 v27, v21, v21
  v_lshlrev_b32 v22, 16, v55
  v_and_b32 v23, v15, v55
  v_add_f32 v24, v24, v22
  v_add_f32 v25, v25, v23
  v_fmac_f32 v26, v22, v22
  v_fmac_f32 v27, v23, v23
  s_waitcnt lgkmcnt(0)
  v_mfma_f32_32x32x16_bf16 v[32:47], v[48:51], v[56:59], v[32:47]
  ds_read_b128 v[52:55], v10 offset:28672
  ds_read_b64_tr_b16 v[60:61], v14 offset:53248
  ds_read_b64_tr_b16 v[62:63], v14 offset:53504
  v_lshlrev_b32 v20, 16, v48
  v_and_b32 v21, v15, v48
  v_add_f32 v24, v24, v20
  v_add_f32 v25, v25, v21
  v_fmac_f32 v26, v20, v20
  v_fmac_f32 v27, v21, v21
  v_lshlrev_b32 v22, 16, v49
  v_and_b32 v23, v15, v49
  v_add_f32 v24, v24, v22
  v_add_f32 v25, v25, v23
  v_fmac_f32 v26, v22, v22
  v_fmac_f32 v27, v23, v23
  v_lshlrev_b32 v20, 16, v50
  v_and_b32 v21, v15, v50
  v_add_f32 v24, v24, v20
  v_add_f32 v25, v25, v21
  v_fmac_f32 v26, v20, v20
  v_fmac_f32 v27, v21, v21
  v_lshlrev_b32 v22, 16, v51
  v_and_b32 v23, v15, v51
  v_add_f32 v24, v24, v22
  v_add_f32 v25, v25, v23
  v_fmac_f32 v26, v22, v22
  v_fmac_f32 v27, v23, v23
  s_waitcnt lgkmcnt(0)
  v_add_u32 v7, 57344, v7
  v_add_u32 v8, 57344, v8
  v_add_u32 v9, 57344, v9
  v_add_u32 v10, 57344, v10
  v_add_u32 v11, 57344, v11
  v_add_u32 v12, 57344, v12
  v_add_u32 v13, 57344, v13
  v_add_u32 v14, 57344, v14
  s_barrier
  v_mfma_f32_32x32x16_bf16 v[32:47], v[52:55], v[60:63], v[32:47]
  ds_read_b128 v[48:51], v7 offset:0
  ds_read_b64_tr_b16 v[56:57], v11 offset:24576
  ds_read_b64_tr_b16 v[58:59], v11 offset:24832
  v_lshlrev_b32 v20, 16, v52
  v_and_b32 v21, v15, v52
  v_add_f32 v24, v24, v20
  v_add_f32 v25, v25, v21
  v_fmac_f32 v26, v20, v20
  v_fmac_f32 v27, v21, v21
  v_lshlrev_b32 v22, 16, v53
  v_and_b32 v23, v15, v53
  v_add_f32 v24, v24, v22
  v_add_f32 v25, v25, v23
  v_fmac_f32 v26, v22, v22
  v_fmac_f32 v27, v23, v23
  v_lshlrev_b32 v20, 16, v54
  v_and_b32 v21, v15, v54
  v_add_f32 v24, v24, v20
  v_add_f32 v25, v25, v21
  v_fmac_f32 v26, v20, v20
  v_fmac_f32 v27, v21, v21
  v_lshlrev_b32 v22, 16, v55
  v_and_b32 v23, v15, v55
  v_add_f32 v24, v24, v22
  v_add_f32 v25, v25, v23
  v_fmac_f32 v26, v22, v22
  v_fmac_f32 v27, v23, v23
  s_waitcnt lgkmcnt(0)
  v_mfma_f32_32x32x16_bf16 v[32:47], v[48:51], v[56:59], v[32:47]
  ds_read_b128 v[52:55], v8 offset:0
  ds_read_b64_tr_b16 v[60:61], v12 offset:24576
  ds_read_b64_tr_b16 v[62:63], v12 offset:24832
  v_lshlrev_b32 v20, 16, v48
  v_and_b32 v21, v15, v48
  v_add_f32 v24, v24, v20
  v_add_f32 v25, v25, v21
  v_fmac_f32 v26, v20, v20
  v_fmac_f32 v27, v21, v21
  v_lshlrev_b32 v22, 16, v49
  v_and_b32 v23, v15, v49
  v_add_f32 v24, v24, v22
  v_add_f32 v25, v25, v23
  v_fmac_f32 v26, v22, v22
  v_fmac_f32 v27, v23, v23
  v_lshlrev_b32 v20, 16, v50
  v_and_b32 v21, v15, v50
  v_add_f32 v24, v24, v20
  v_add_f32 v25, v25, v21
  v_fmac_f32 v26, v20, v20
  v_fmac_f32 v27, v21, v21
  v_lshlrev_b32 v22, 16, v51
  v_and_b32 v23, v15, v51
  v_add_f32 v24, v24, v22
  v_add_f32 v25, v25, v23
  v_fmac_f32 v26, v22, v22
  v_fmac_f32 v27, v23, v23
  v_mfma_f32_16x16x32_bf16 v[64:67], v[56:59], v[16:19], v[64:67]
  s_waitcnt lgkmcnt(0)
  v_mfma_f32_32x32x16_bf16 v[32:47], v[52:55], v[60:63], v[32:47]
  ds_read_b128 v[48:51], v9 offset:0
  ds_read_b64_tr_b16 v[56:57], v13 offset:24576
  ds_read_b64_tr_b16 v[58:59], v13 offset:24832
  v_lshlrev_b32 v20, 16, v52
  v_and_b32 v21, v15, v52
  v_add_f32 v24, v24, v20
  v_add_f32 v25, v25, v21
  v_fmac_f32 v26, v20, v20
  v_fmac_f32 v27, v21, v21
  v_lshlrev_b32 v22, 16, v53
  v_and_b32 v23, v15, v53
  v_add_f32 v24, v24, v22
  v_add_f32 v25, v25, v23
  v_fmac_f32 v26, v22, v22
  v_fmac_f32 v27, v23, v23
  v_lshlrev_b32 v20, 16, v54
  v_and_b32 v21, v15, v54
  v_add_f32 v24, v24, v20
  v_add_f32 v25, v25, v21
  v_fmac_f32 v26, v20, v20
  v_fmac_f32 v27, v21, v21
  v_lshlrev_b32 v22, 16, v55
  v_and_b32 v23, v15, v55
  v_add_f32 v24, v24, v22
  v_add_f32 v25, v25, v23
  v_fmac_f32 v26, v22, v22
  v_fmac_f32 v27, v23, v23
  s_waitcnt lgkmcnt(0)
  v_mfma_f32_32x32x16_bf16 v[32:47], v[48:51], v[56:59], v[32:47]
  ds_read_b128 v[52:55], v10 offset:0
  ds_read_b64_tr_b16 v[60:61], v14 offset:24576
  ds_read_b64_tr_b16 v[62:63], v14 offset:24832
  v_lshlrev_b32 v20, 16, v48
  v_and_b32 v21, v15, v48
  v_add_f32 v24, v24, v20
  v_add_f32 v25, v25, v21
  v_fmac_f32 v26, v20, v20
  v_fmac_f32 v27, v21, v21
  v_lshlrev_b32 v22, 16, v49
  v_and_b32 v23, v15, v49
  v_add_f32 v24, v24, v22
  v_add_f32 v25, v25, v23
  v_fmac_f32 v26, v22, v22
  v_fmac_f32 v27, v23, v23
  v_lshlrev_b32 v20, 16, v50
  v_and_b32 v21, v15, v50
  v_add_f32 v24, v24, v20
  v_add_f32 v25, v25, v21
  v_fmac_f32 v26, v20, v20
  v_fmac_f32 v27, v21, v21
  v_lshlrev_b32 v22, 16, v51
  v_and_b32 v23, v15, v51
  v_add_f32 v24, v24, v22
  v_add_f32 v25, v25, v23
  v_fmac_f32 v26, v22, v22
  v_fmac_f32 v27, v23, v23
  s_waitcnt lgkmcnt(0)
  v_mfma_f32_32x32x16_bf16 v[32:47], v[52:55], v[60:63], v[32:47]
  v_lshlrev_b32 v20, 16, v52
  v_and_b32 v21, v15, v52
  v_add_f32 v24, v24, v20
  v_add_f32 v25, v25, v21
  v_fmac_f32 v26, v20, v20
  v_fmac_f32 v27, v21, v21
  v_lshlrev_b32 v22, 16, v53
  v_and_b32 v23, v15, v53
  v_add_f32 v24, v24, v22
  v_add_f32 v25, v25, v23
  v_fmac_f32 v26, v22, v22
  v_fmac_f32 v27, v23, v23
  v_lshlrev_b32 v20, 16, v54
  v_and_b32 v21, v15, v54
  v_add_f32 v24, v24, v20
  v_add_f32 v25, v25, v21
  v_fmac_f32 v26, v20, v20
  v_fmac_f32 v27, v21, v21
  v_lshlrev_b32 v22, 16, v55
  v_and_b32 v23, v15, v55
  v_add_f32 v24, v24, v22
  v_add_f32 v25, v25, v23
  v_fmac_f32 v26, v22, v22
  v_fmac_f32 v27, v23, v23
  s_setprio 0
  s_mov_b32 exec_lo, 0x00030003
  s_mov_b32 exec_hi, 0x00030003
  ds_write_b128 v71, v[64:67]
  s_mov_b64 exec, -1
  v_add_f32 v24, v24, v25
  v_mov_b32 v68, v24
  s_nop 1
  v_permlane32_swap_b32 v24, v68
  v_add_f32 v24, v24, v68
  v_add_f32 v26, v26, v27
  v_mov_b32 v68, v26
  s_nop 1
  v_permlane32_swap_b32 v26, v68
  v_add_f32 v26, v26, v68
  v_mul_f32 v24, 0x3b000000, v24
  v_mul_f32 v68, v24, v24
  v_mov_b32 v75, 0x3b000000
  v_fma_f32 v26, v26, v75, -v68
  v_max_f32 v26, 0, v26
  v_add_f32 v26, 0x3727c5ac, v26
  v_rsq_f32 v75, v26
  s_nop 0
  v_mul_f32 v76, v24, v75
  v_sub_f32 v24, 0, v24
  ds_write_b32 v70, v75
  ds_write_b32 v70, v76 offset:512
  ds_write_b32 v70, v24 offset:1024
  v_mov_b32 v68, 156800
  s_waitcnt lgkmcnt(0)
  s_barrier
  ds_read_b32 v77, v68
  ds_read_b32 v80, v69 offset:0
  ds_read_b32 v81, v69 offset:128
  ds_read_b32 v82, v69 offset:256
  ds_read_b32 v83, v69 offset:384
  ds_read_b128 v[84:87], v72 offset:0
  ds_read_b128 v[88:91], v72 offset:32
  ds_read_b128 v[92:95], v72 offset:64
  ds_read_b128 v[96:99], v72 offset:96
  ds_read_b128 v[100:103], v72 offset:512
  ds_read_b128 v[104:107], v72 offset:544
  ds_read_b128 v[108:111], v72 offset:576
  ds_read_b128 v[112:115], v72 offset:608
  s_waitcnt lgkmcnt(8)
  v_readfirstlane_b32 s39, v77
  v_add_f32 v80, v80, v81
  v_add_f32 v82, v82, v83
  v_add_f32 v64, v80, v82
  s_waitcnt lgkmcnt(4)
  v_pk_mul_f32 v[32:33], v[32:33], v[84:85]
  v_pk_mul_f32 v[34:35], v[34:35], v[86:87]
  v_pk_mul_f32 v[36:37], v[36:37], v[88:89]
  v_pk_mul_f32 v[38:39], v[38:39], v[90:91]
  v_pk_mul_f32 v[40:41], v[40:41], v[92:93]
  v_pk_mul_f32 v[42:43], v[42:43], v[94:95]
  v_pk_mul_f32 v[44:45], v[44:45], v[96:97]
  v_pk_mul_f32 v[46:47], v[46:47], v[98:99]
  v_sub_f32 v64, 0, v64
  s_waitcnt lgkmcnt(0)
  v_pk_fma_f32 v[32:33], v[100:101], v[64:65], v[32:33] op_sel_hi:[1,0,1]
  v_pk_fma_f32 v[34:35], v[102:103], v[64:65], v[34:35] op_sel_hi:[1,0,1]
  v_pk_fma_f32 v[36:37], v[104:105], v[64:65], v[36:37] op_sel_hi:[1,0,1]
  v_pk_fma_f32 v[38:39], v[106:107], v[64:65], v[38:39] op_sel_hi:[1,0,1]
  v_pk_fma_f32 v[40:41], v[108:109], v[64:65], v[40:41] op_sel_hi:[1,0,1]
  v_pk_fma_f32 v[42:43], v[110:111], v[64:65], v[42:43] op_sel_hi:[1,0,1]
  v_pk_fma_f32 v[44:45], v[112:113], v[64:65], v[44:45] op_sel_hi:[1,0,1]
  v_pk_fma_f32 v[46:47], v[114:115], v[64:65], v[46:47] op_sel_hi:[1,0,1]
  v_cvt_pk_bf16_f32 v116, v32, v33
  v_cvt_pk_bf16_f32 v117, v34, v35
  v_cvt_pk_bf16_f32 v118, v36, v37
  v_cvt_pk_bf16_f32 v119, v38, v39
  v_cvt_pk_bf16_f32 v120, v40, v41
  v_cvt_pk_bf16_f32 v121, v42, v43
  v_cvt_pk_bf16_f32 v122, v44, v45
  v_cvt_pk_bf16_f32 v123, v46, v47
  s_cmp_eq_u32 s39, 0
  s_cbranch_scc1 L_st_slow_3
  buffer_store_dwordx4 v[116:119], v73, s[28:31], s62 offen
  buffer_store_dwordx4 v[120:123], v73, s[28:31], s62 offen offset:512
  s_branch L_st_done_4
L_st_slow_3:
  buffer_store_dwordx4 v[116:119], v73, s[28:31], s62 offen sc1
  buffer_store_dwordx4 v[120:123], v73, s[28:31], s62 offen offset:512 sc1
L_st_done_4:
  ds_write_b128 v74, v[116:119]
  ds_write_b128 v74, v[120:123] offset:512
  s_waitcnt vmcnt(0) lgkmcnt(0)
  s_barrier
  s_and_b32 s44, s36, 3
  s_lshl_b32 s44, s44, 10
  s_add_u32 s44, s44, 148992
  v_add_u32 v69, s44, v2
  ds_read_b128 v[28:31], v69
  s_waitcnt lgkmcnt(0)
L_p1_join:
  s_lshr_b32 s44, s36, 2
  s_lshl_b32 s64, s37, 1
  s_add_u32 s64, s64, s44
  s_lshl_b32 s44, s44, 13
  v_add_u32 v104, s44, v2
  v_lshrrev_b32 v106, 5, v1
  v_lshlrev_b32 v106, 8, v106
  v_and_b32 v107, 15, v1
  v_lshl_add_u32 v106, v107, 4, v106
  s_add_u32 s44, s44, 4096
  v_add_u32 v105, s44, v106
L_attn_begin:
  v_and_b32 v106, 31, v1
  v_cmp_eq_u32 vcc, 16, v106
  v_mov_b32 v107, 0x3f803f80
  s_nop 0
  v_cndmask_b32 v106, 0, v107, vcc
  v_mov_b32 v88, v106
  v_mov_b32 v89, v106
  v_mov_b32 v90, v106
  v_mov_b32 v91, v106
  v_mov_b32 v92, v106
  v_mov_b32 v93, v106
  v_mov_b32 v94, v106
  v_mov_b32 v95, v106
  v_mov_b32 v96, v106
  v_mov_b32 v97, v106
  v_mov_b32 v98, v106
  v_mov_b32 v99, v106
  v_mov_b32 v100, v106
  v_mov_b32 v101, v106
  v_mov_b32 v102, v106
  v_mov_b32 v103, v106
  v_mov_b32 v64, 0
  v_mov_b32 v65, 0
  v_mov_b32 v66, 0
  v_mov_b32 v67, 0
  v_mov_b32 v68, 0
  v_mov_b32 v69, 0
  v_mov_b32 v70, 0
  v_mov_b32 v71, 0
  v_mov_b32 v72, 0
  v_mov_b32 v73, 0
  v_mov_b32 v74, 0
  v_mov_b32 v75, 0
  v_mov_b32 v76, 0
  v_mov_b32 v77, 0
  v_mov_b32 v78, 0
  v_mov_b32 v79, 0
  v_mov_b32 v24, 0
  v_mov_b32 v25, 0
  v_mov_b32 v26, 0
  v_mov_b32 v27, 0
  ds_read_b128 v[80:83], v104 offset:0
  ds_read_b128 v[84:87], v104 offset:1024
  s_mov_b64 exec, s[54:55]
  ds_read_b128 v[88:91], v105 offset:0
  ds_read_b128 v[92:95], v105 offset:512
  s_mov_b64 exec, -1
  s_waitcnt lgkmcnt(3)
  s_cmp_lg_u32 s42, 0
  s_cbranch_scc1 L_skip_max_7
  v_mfma_f32_32x32x16_bf16 v[4:19], v[80:83], v[28:31], 0
  s_nop 11
  v_max3_f32 v106, v4, v5, v6
  v_max3_f32 v106, v106, v7, v8
  v_max3_f32 v106, v106, v9, v10
  v_max3_f32 v106, v106, v11, v12
  v_max3_f32 v106, v106, v13, v14
  v_max3_f32 v106, v106, v15, v16
  v_max3_f32 v106, v106, v17, v18
  v_max_f32 v106, v106, v19
  v_mov_b32 v107, v106
  s_nop 1
  v_permlane32_swap_b32 v106, v107
  v_max_f32 v106, v106, v107
  v_sub_f32 v48, 0, v106
  v_sub_f32 v49, 0, v106
  v_sub_f32 v50, 0, v106
  v_sub_f32 v51, 0, v106
  v_sub_f32 v52, 0, v106
  v_sub_f32 v53, 0, v106
  v_sub_f32 v54, 0, v106
  v_sub_f32 v55, 0, v106
  v_sub_f32 v56, 0, v106
  v_sub_f32 v57, 0, v106
  v_sub_f32 v58, 0, v106
  v_sub_f32 v59, 0, v106
  v_sub_f32 v60, 0, v106
  v_sub_f32 v61, 0, v106
  v_sub_f32 v62, 0, v106
  v_sub_f32 v63, 0, v106
L_skip_max_7:
  s_nop 1
  v_mfma_f32_32x32x16_bf16 v[4:19], v[80:83], v[28:31], v[48:63]
  s_nop 8
  s_mov_b32 s66, 4
L_attn_loop:
  s_setprio 1
  s_waitcnt lgkmcnt(0)
  v_mfma_f32_32x32x16_bf16 v[32:47], v[84:87], v[28:31], v[48:63]
  v_exp_f32 v4, v4
  v_exp_f32 v5, v5
  v_exp_f32 v6, v6
  v_exp_f32 v7, v7
  v_mfma_f32_32x32x16_bf16 v[64:79], v[100:103], v[24:27], v[64:79]
  s_mov_b64 exec, s[54:55]
  ds_read_b128 v[96:99], v105 offset:1024
  ds_read_b128 v[100:103], v105 offset:1536
  s_mov_b64 exec, -1
  v_cvt_pk_bf16_f32 v20, v4, v5
  v_exp_f32 v8, v8
  v_exp_f32 v9, v9
  v_cvt_pk_bf16_f32 v21, v6, v7
  v_exp_f32 v10, v10
  v_exp_f32 v11, v11
  v_cvt_pk_bf16_f32 v22, v8, v9
  v_exp_f32 v12, v12
  v_cvt_pk_bf16_f32 v23, v10, v11
  v_exp_f32 v13, v13
  v_exp_f32 v14, v14
  v_mfma_f32_32x32x16_bf16 v[64:79], v[88:91], v[20:23], v[64:79]
  ds_read_b128 v[80:83], v104 offset:2048
  v_exp_f32 v15, v15
  v_cvt_pk_bf16_f32 v24, v12, v13
  v_exp_f32 v16, v16
  v_exp_f32 v17, v17
  v_cvt_pk_bf16_f32 v25, v14, v15
  v_exp_f32 v18, v18
  v_exp_f32 v19, v19
  v_cvt_pk_bf16_f32 v26, v16, v17
  v_cvt_pk_bf16_f32 v27, v18, v19
  s_setprio 0
  s_waitcnt lgkmcnt(0)
  v_mfma_f32_32x32x16_bf16 v[4:19], v[80:83], v[28:31], v[48:63]
  v_exp_f32 v32, v32
  v_exp_f32 v33, v33
  v_exp_f32 v34, v34
  v_exp_f32 v35, v35
  v_mfma_f32_32x32x16_bf16 v[64:79], v[92:95], v[24:27], v[64:79]
  s_mov_b64 exec, s[54:55]
  ds_read_b128 v[88:91], v105 offset:2048
  ds_read_b128 v[92:95], v105 offset:2560
  s_mov_b64 exec, -1
  v_cvt_pk_bf16_f32 v20, v32, v33
  v_exp_f32 v36, v36
  v_exp_f32 v37, v37
  v_cvt_pk_bf16_f32 v21, v34, v35
  v_exp_f32 v38, v38
  v_exp_f32 v39, v39
  v_cvt_pk_bf16_f32 v22, v36, v37
  v_exp_f32 v40, v40
  v_cvt_pk_bf16_f32 v23, v38, v39
  v_exp_f32 v41, v41
  v_exp_f32 v42, v42
  v_mfma_f32_32x32x16_bf16 v[64:79], v[96:99], v[20:23], v[64:79]
  ds_read_b128 v[84:87], v104 offset:3072
  v_exp_f32 v43, v43
  v_cvt_pk_bf16_f32 v24, v40, v41
  v_exp_f32 v44, v44
  v_exp_f32 v45, v45
  v_cvt_pk_bf16_f32 v25, v42, v43
  v_exp_f32 v46, v46
  v_exp_f32 v47, v47
  v_cvt_pk_bf16_f32 v26, v44, v45
  v_cvt_pk_bf16_f32 v27, v46, v47
  s_setprio 3
  s_waitcnt lgkmcnt(0)
  v_mfma_f32_32x32x16_bf16 v[32:47], v[84:87], v[28:31], v[48:63]
  v_exp_f32 v4, v4
  v_exp_f32 v5, v5
  v_exp_f32 v6, v6
  v_exp_f32 v7, v7
  v_mfma_f32_32x32x16_bf16 v[64:79], v[100:103], v[24:27], v[64:79]
  s_mov_b64 exec, s[54:55]
  ds_read_b128 v[96:99], v105 offset:3072
  ds_read_b128 v[100:103], v105 offset:3584
  s_mov_b64 exec, -1
  v_cvt_pk_bf16_f32 v20, v4, v5
  v_exp_f32 v8, v8
  v_exp_f32 v9, v9
  v_cvt_pk_bf16_f32 v21, v6, v7
  v_exp_f32 v10, v10
  v_exp_f32 v11, v11
  v_cvt_pk_bf16_f32 v22, v8, v9
  v_exp_f32 v12, v12
  v_cvt_pk_bf16_f32 v23, v10, v11
  v_exp_f32 v13, v13
  v_exp_f32 v14, v14
  v_mfma_f32_32x32x16_bf16 v[64:79], v[88:91], v[20:23], v[64:79]
  s_barrier
  ds_read_b128 v[80:83], v104 offset:16384
  v_exp_f32 v15, v15
  v_cvt_pk_bf16_f32 v24, v12, v13
  v_exp_f32 v16, v16
  v_exp_f32 v17, v17
  v_cvt_pk_bf16_f32 v25, v14, v15
  v_exp_f32 v18, v18
  v_exp_f32 v19, v19
  v_cvt_pk_bf16_f32 v26, v16, v17
  v_cvt_pk_bf16_f32 v27, v18, v19
  s_setprio 2
  s_waitcnt lgkmcnt(0)
  v_mfma_f32_32x32x16_bf16 v[4:19], v[80:83], v[28:31], v[48:63]
  v_exp_f32 v32, v32
  v_exp_f32 v33, v33
  v_exp_f32 v34, v34
  v_exp_f32 v35, v35
  v_mfma_f32_32x32x16_bf16 v[64:79], v[92:95], v[24:27], v[64:79]
  s_mov_b64 exec, s[54:55]
  ds_read_b128 v[88:91], v105 offset:16384
  ds_read_b128 v[92:95], v105 offset:16896
  s_mov_b64 exec, -1
  v_cvt_pk_bf16_f32 v20, v32, v33
  v_exp_f32 v36, v36
  v_exp_f32 v37, v37
  v_cvt_pk_bf16_f32 v21, v34, v35
  v_exp_f32 v38, v38
  v_exp_f32 v39, v39
  v_cvt_pk_bf16_f32 v22, v36, v37
  v_exp_f32 v40, v40
  v_cvt_pk_bf16_f32 v23, v38, v39
  v_exp_f32 v41, v41
  v_exp_f32 v42, v42
  v_mfma_f32_32x32x16_bf16 v[64:79], v[96:99], v[20:23], v[64:79]
  ds_read_b128 v[84:87], v104 offset:17408
  v_exp_f32 v43, v43
  v_cvt_pk_bf16_f32 v24, v40, v41
  v_exp_f32 v44, v44
  v_exp_f32 v45, v45
  v_cvt_pk_bf16_f32 v25, v42, v43
  v_exp_f32 v46, v46
  v_exp_f32 v47, v47
  v_cvt_pk_bf16_f32 v26, v44, v45
  v_cvt_pk_bf16_f32 v27, v46, v47
  s_setprio 1
  s_waitcnt lgkmcnt(0)
  v_mfma_f32_32x32x16_bf16 v[32:47], v[84:87], v[28:31], v[48:63]
  v_exp_f32 v4, v4
  v_exp_f32 v5, v5
  v_exp_f32 v6, v6
  v_exp_f32 v7, v7
  v_mfma_f32_32x32x16_bf16 v[64:79], v[100:103], v[24:27], v[64:79]
  s_mov_b64 exec, s[54:55]
  ds_read_b128 v[96:99], v105 offset:17408
  ds_read_b128 v[100:103], v105 offset:17920
  s_mov_b64 exec, -1
  v_cvt_pk_bf16_f32 v20, v4, v5
  v_exp_f32 v8, v8
  v_exp_f32 v9, v9
  v_cvt_pk_bf16_f32 v21, v6, v7
  v_exp_f32 v10, v10
  v_exp_f32 v11, v11
  v_cvt_pk_bf16_f32 v22, v8, v9
  v_exp_f32 v12, v12
  v_cvt_pk_bf16_f32 v23, v10, v11
  v_exp_f32 v13, v13
  v_exp_f32 v14, v14
  v_mfma_f32_32x32x16_bf16 v[64:79], v[88:91], v[20:23], v[64:79]
  ds_read_b128 v[80:83], v104 offset:18432
  v_exp_f32 v15, v15
  v_cvt_pk_bf16_f32 v24, v12, v13
  v_exp_f32 v16, v16
  v_exp_f32 v17, v17
  v_cvt_pk_bf16_f32 v25, v14, v15
  v_exp_f32 v18, v18
  v_exp_f32 v19, v19
  v_cvt_pk_bf16_f32 v26, v16, v17
  v_cvt_pk_bf16_f32 v27, v18, v19
  s_setprio 0
  s_waitcnt lgkmcnt(0)
  v_mfma_f32_32x32x16_bf16 v[4:19], v[80:83], v[28:31], v[48:63]
  v_exp_f32 v32, v32
  v_exp_f32 v33, v33
  v_exp_f32 v34, v34
  v_exp_f32 v35, v35
  v_mfma_f32_32x32x16_bf16 v[64:79], v[92:95], v[24:27], v[64:79]
  s_mov_b64 exec, s[54:55]
  ds_read_b128 v[88:91], v105 offset:18432
  ds_read_b128 v[92:95], v105 offset:18944
  s_mov_b64 exec, -1
  v_cvt_pk_bf16_f32 v20, v32, v33
  v_exp_f32 v36, v36
  v_exp_f32 v37, v37
  v_cvt_pk_bf16_f32 v21, v34, v35
  v_exp_f32 v38, v38
  v_exp_f32 v39, v39
  v_cvt_pk_bf16_f32 v22, v36, v37
  v_exp_f32 v40, v40
  v_cvt_pk_bf16_f32 v23, v38, v39
  v_exp_f32 v41, v41
  v_exp_f32 v42, v42
  v_mfma_f32_32x32x16_bf16 v[64:79], v[96:99], v[20:23], v[64:79]
  ds_read_b128 v[84:87], v104 offset:19456
  v_exp_f32 v43, v43
  v_cvt_pk_bf16_f32 v24, v40, v41
  v_exp_f32 v44, v44
  v_exp_f32 v45, v45
  v_cvt_pk_bf16_f32 v25, v42, v43
  v_exp_f32 v46, v46
  v_exp_f32 v47, v47
  v_cvt_pk_bf16_f32 v26, v44, v45
  v_cvt_pk_bf16_f32 v27, v46, v47
  s_setprio 3
  s_waitcnt lgkmcnt(0)
  v_mfma_f32_32x32x16_bf16 v[32:47], v[84:87], v[28:31], v[48:63]
  v_exp_f32 v4, v4
  v_exp_f32 v5, v5
  v_exp_f32 v6, v6
  v_exp_f32 v7, v7
  v_mfma_f32_32x32x16_bf16 v[64:79], v[100:103], v[24:27], v[64:79]
  s_mov_b64 exec, s[54:55]
  ds_read_b128 v[96:99], v105 offset:19456
  ds_read_b128 v[100:103], v105 offset:19968
  s_mov_b64 exec, -1
  v_cvt_pk_bf16_f32 v20, v4, v5
  v_exp_f32 v8, v8
  v_exp_f32 v9, v9
  v_cvt_pk_bf16_f32 v21, v6, v7
  v_exp_f32 v10, v10
  v_exp_f32 v11, v11
  v_cvt_pk_bf16_f32 v22, v8, v9
  v_exp_f32 v12, v12
  v_cvt_pk_bf16_f32 v23, v10, v11
  v_exp_f32 v13, v13
  v_exp_f32 v14, v14
  v_mfma_f32_32x32x16_bf16 v[64:79], v[88:91], v[20:23], v[64:79]
  s_barrier
  ds_read_b128 v[80:83], v104 offset:32768
  v_exp_f32 v15, v15
  v_cvt_pk_bf16_f32 v24, v12, v13
  v_exp_f32 v16, v16
  v_exp_f32 v17, v17
  v_cvt_pk_bf16_f32 v25, v14, v15
  v_exp_f32 v18, v18
  v_exp_f32 v19, v19
  v_cvt_pk_bf16_f32 v26, v16, v17
  v_cvt_pk_bf16_f32 v27, v18, v19
  s_setprio 2
  s_waitcnt lgkmcnt(0)
  v_mfma_f32_32x32x16_bf16 v[4:19], v[80:83], v[28:31], v[48:63]
  v_exp_f32 v32, v32
  v_exp_f32 v33, v33
  v_exp_f32 v34, v34
  v_exp_f32 v35, v35
  v_mfma_f32_32x32x16_bf16 v[64:79], v[92:95], v[24:27], v[64:79]
  s_mov_b64 exec, s[54:55]
  ds_read_b128 v[88:91], v105 offset:32768
  ds_read_b128 v[92:95], v105 offset:33280
  s_mov_b64 exec, -1
  v_cvt_pk_bf16_f32 v20, v32, v33
  v_exp_f32 v36, v36
  v_exp_f32 v37, v37
  v_cvt_pk_bf16_f32 v21, v34, v35
  v_exp_f32 v38, v38
  v_exp_f32 v39, v39
  v_cvt_pk_bf16_f32 v22, v36, v37
  v_exp_f32 v40, v40
  v_cvt_pk_bf16_f32 v23, v38, v39
  v_exp_f32 v41, v41
  v_exp_f32 v42, v42
  v_mfma_f32_32x32x16_bf16 v[64:79], v[96:99], v[20:23], v[64:79]
  ds_read_b128 v[84:87], v104 offset:33792
  v_exp_f32 v43, v43
  v_cvt_pk_bf16_f32 v24, v40, v41
  v_exp_f32 v44, v44
  v_exp_f32 v45, v45
  v_cvt_pk_bf16_f32 v25, v42, v43
  v_exp_f32 v46, v46
  v_exp_f32 v47, v47
  v_cvt_pk_bf16_f32 v26, v44, v45
  v_cvt_pk_bf16_f32 v27, v46, v47
  s_setprio 1
  s_waitcnt lgkmcnt(0)
  v_mfma_f32_32x32x16_bf16 v[32:47], v[84:87], v[28:31], v[48:63]
  v_exp_f32 v4, v4
  v_exp_f32 v5, v5
  v_exp_f32 v6, v6
  v_exp_f32 v7, v7
  v_mfma_f32_32x32x16_bf16 v[64:79], v[100:103], v[24:27], v[64:79]
  s_mov_b64 exec, s[54:55]
  ds_read_b128 v[96:99], v105 offset:33792
  ds_read_b128 v[100:103], v105 offset:34304
  s_mov_b64 exec, -1
  v_cvt_pk_bf16_f32 v20, v4, v5
  v_exp_f32 v8, v8
  v_exp_f32 v9, v9
  v_cvt_pk_bf16_f32 v21, v6, v7
  v_exp_f32 v10, v10
  v_exp_f32 v11, v11
  v_cvt_pk_bf16_f32 v22, v8, v9
  v_exp_f32 v12, v12
  v_cvt_pk_bf16_f32 v23, v10, v11
  v_exp_f32 v13, v13
  v_exp_f32 v14, v14
  v_mfma_f32_32x32x16_bf16 v[64:79], v[88:91], v[20:23], v[64:79]
  ds_read_b128 v[80:83], v104 offset:34816
  v_exp_f32 v15, v15
  v_cvt_pk_bf16_f32 v24, v12, v13
  v_exp_f32 v16, v16
  v_exp_f32 v17, v17
  v_cvt_pk_bf16_f32 v25, v14, v15
  v_exp_f32 v18, v18
  v_exp_f32 v19, v19
  v_cvt_pk_bf16_f32 v26, v16, v17
  v_cvt_pk_bf16_f32 v27, v18, v19
  s_setprio 0
  s_waitcnt lgkmcnt(0)
  v_mfma_f32_32x32x16_bf16 v[4:19], v[80:83], v[28:31], v[48:63]
  v_exp_f32 v32, v32
  v_exp_f32 v33, v33
  v_exp_f32 v34, v34
  v_exp_f32 v35, v35
  v_mfma_f32_32x32x16_bf16 v[64:79], v[92:95], v[24:27], v[64:79]
  s_mov_b64 exec, s[54:55]
  ds_read_b128 v[88:91], v105 offset:34816
  ds_read_b128 v[92:95], v105 offset:35328
  s_mov_b64 exec, -1
  v_cvt_pk_bf16_f32 v20, v32, v33
  v_exp_f32 v36, v36
  v_exp_f32 v37, v37
  v_cvt_pk_bf16_f32 v21, v34, v35
  v_exp_f32 v38, v38
  v_exp_f32 v39, v39
  v_cvt_pk_bf16_f32 v22, v36, v37
  v_exp_f32 v40, v40
  v_cvt_pk_bf16_f32 v23, v38, v39
  v_exp_f32 v41, v41
  v_exp_f32 v42, v42
  v_mfma_f32_32x32x16_bf16 v[64:79], v[96:99], v[20:23], v[64:79]
  ds_read_b128 v[84:87], v104 offset:35840
  v_exp_f32 v43, v43
  v_cvt_pk_bf16_f32 v24, v40, v41
  v_exp_f32 v44, v44
  v_exp_f32 v45, v45
  v_cvt_pk_bf16_f32 v25, v42, v43
  v_exp_f32 v46, v46
  v_exp_f32 v47, v47
  v_cvt_pk_bf16_f32 v26, v44, v45
  v_cvt_pk_bf16_f32 v27, v46, v47
  s_setprio 3
  s_waitcnt lgkmcnt(0)
  v_mfma_f32_32x32x16_bf16 v[32:47], v[84:87], v[28:31], v[48:63]
  v_exp_f32 v4, v4
  v_exp_f32 v5, v5
  v_exp_f32 v6, v6
  v_exp_f32 v7, v7
  v_mfma_f32_32x32x16_bf16 v[64:79], v[100:103], v[24:27], v[64:79]
  s_mov_b64 exec, s[54:55]
  ds_read_b128 v[96:99], v105 offset:35840
  ds_read_b128 v[100:103], v105 offset:36352
  s_mov_b64 exec, -1
  v_cvt_pk_bf16_f32 v20, v4, v5
  v_exp_f32 v8, v8
  v_exp_f32 v9, v9
  v_cvt_pk_bf16_f32 v21, v6, v7
  v_exp_f32 v10, v10
  v_exp_f32 v11, v11
  v_cvt_pk_bf16_f32 v22, v8, v9
  v_exp_f32 v12, v12
  v_cvt_pk_bf16_f32 v23, v10, v11
  v_exp_f32 v13, v13
  v_exp_f32 v14, v14
  v_mfma_f32_32x32x16_bf16 v[64:79], v[88:91], v[20:23], v[64:79]
  s_barrier
  ds_read_b128 v[80:83], v104 offset:49152
  v_exp_f32 v15, v15
  v_cvt_pk_bf16_f32 v24, v12, v13
  v_exp_f32 v16, v16
  v_exp_f32 v17, v17
  v_cvt_pk_bf16_f32 v25, v14, v15
  v_exp_f32 v18, v18
  v_exp_f32 v19, v19
  v_cvt_pk_bf16_f32 v26, v16, v17
  v_cvt_pk_bf16_f32 v27, v18, v19
  s_setprio 2
  s_waitcnt lgkmcnt(0)
  v_mfma_f32_32x32x16_bf16 v[4:19], v[80:83], v[28:31], v[48:63]
  v_exp_f32 v32, v32
  v_exp_f32 v33, v33
  v_exp_f32 v34, v34
  v_exp_f32 v35, v35
  v_mfma_f32_32x32x16_bf16 v[64:79], v[92:95], v[24:27], v[64:79]
  s_mov_b64 exec, s[54:55]
  ds_read_b128 v[88:91], v105 offset:49152
  ds_read_b128 v[92:95], v105 offset:49664
  s_mov_b64 exec, -1
  v_cvt_pk_bf16_f32 v20, v32, v33
  v_exp_f32 v36, v36
  v_exp_f32 v37, v37
  v_cvt_pk_bf16_f32 v21, v34, v35
  v_exp_f32 v38, v38
  v_exp_f32 v39, v39
  v_cvt_pk_bf16_f32 v22, v36, v37
  v_exp_f32 v40, v40
  v_cvt_pk_bf16_f32 v23, v38, v39
  v_exp_f32 v41, v41
  v_exp_f32 v42, v42
  v_mfma_f32_32x32x16_bf16 v[64:79], v[96:99], v[20:23], v[64:79]
  ds_read_b128 v[84:87], v104 offset:50176
  v_exp_f32 v43, v43
  v_cvt_pk_bf16_f32 v24, v40, v41
  v_exp_f32 v44, v44
  v_exp_f32 v45, v45
  v_cvt_pk_bf16_f32 v25, v42, v43
  v_exp_f32 v46, v46
  v_exp_f32 v47, v47
  v_cvt_pk_bf16_f32 v26, v44, v45
  v_cvt_pk_bf16_f32 v27, v46, v47
  s_setprio 1
  s_waitcnt lgkmcnt(0)
  v_mfma_f32_32x32x16_bf16 v[32:47], v[84:87], v[28:31], v[48:63]
  v_exp_f32 v4, v4
  v_exp_f32 v5, v5
  v_exp_f32 v6, v6
  v_exp_f32 v7, v7
  v_mfma_f32_32x32x16_bf16 v[64:79], v[100:103], v[24:27], v[64:79]
  s_mov_b64 exec, s[54:55]
  ds_read_b128 v[96:99], v105 offset:50176
  ds_read_b128 v[100:103], v105 offset:50688
  s_mov_b64 exec, -1
  v_cvt_pk_bf16_f32 v20, v4, v5
  v_exp_f32 v8, v8
  v_exp_f32 v9, v9
  v_cvt_pk_bf16_f32 v21, v6, v7
  v_exp_f32 v10, v10
  v_exp_f32 v11, v11
  v_cvt_pk_bf16_f32 v22, v8, v9
  v_exp_f32 v12, v12
  v_cvt_pk_bf16_f32 v23, v10, v11
  v_exp_f32 v13, v13
  v_exp_f32 v14, v14
  v_mfma_f32_32x32x16_bf16 v[64:79], v[88:91], v[20:23], v[64:79]
  ds_read_b128 v[80:83], v104 offset:51200
  v_exp_f32 v15, v15
  v_cvt_pk_bf16_f32 v24, v12, v13
  v_exp_f32 v16, v16
  v_exp_f32 v17, v17
  v_cvt_pk_bf16_f32 v25, v14, v15
  v_exp_f32 v18, v18
  v_exp_f32 v19, v19
  v_cvt_pk_bf16_f32 v26, v16, v17
  v_cvt_pk_bf16_f32 v27, v18, v19
  s_setprio 0
  s_waitcnt lgkmcnt(0)
  v_mfma_f32_32x32x16_bf16 v[4:19], v[80:83], v[28:31], v[48:63]
  v_exp_f32 v32, v32
  v_exp_f32 v33, v33
  v_exp_f32 v34, v34
  v_exp_f32 v35, v35
  v_mfma_f32_32x32x16_bf16 v[64:79], v[92:95], v[24:27], v[64:79]
  s_mov_b64 exec, s[54:55]
  ds_read_b128 v[88:91], v105 offset:51200
  ds_read_b128 v[92:95], v105 offset:51712
  s_mov_b64 exec, -1
  v_cvt_pk_bf16_f32 v20, v32, v33
  v_exp_f32 v36, v36
  v_exp_f32 v37, v37
  v_cvt_pk_bf16_f32 v21, v34, v35
  v_exp_f32 v38, v38
  v_exp_f32 v39, v39
  v_cvt_pk_bf16_f32 v22, v36, v37
  v_exp_f32 v40, v40
  v_cvt_pk_bf16_f32 v23, v38, v39
  v_exp_f32 v41, v41
  v_exp_f32 v42, v42
  v_mfma_f32_32x32x16_bf16 v[64:79], v[96:99], v[20:23], v[64:79]
  ds_read_b128 v[84:87], v104 offset:52224
  v_exp_f32 v43, v43
  v_cvt_pk_bf16_f32 v24, v40, v41
  v_exp_f32 v44, v44
  v_exp_f32 v45, v45
  v_cvt_pk_bf16_f32 v25, v42, v43
  v_exp_f32 v46, v46
  v_exp_f32 v47, v47
  v_cvt_pk_bf16_f32 v26, v44, v45
  v_cvt_pk_bf16_f32 v27, v46, v47
  s_setprio 3
  s_waitcnt lgkmcnt(0)
  v_mfma_f32_32x32x16_bf16 v[32:47], v[84:87], v[28:31], v[48:63]
  v_exp_f32 v4, v4
  v_exp_f32 v5, v5
  v_exp_f32 v6, v6
  v_exp_f32 v7, v7
  v_mfma_f32_32x32x16_bf16 v[64:79], v[100:103], v[24:27], v[64:79]
  s_mov_b64 exec, s[54:55]
  ds_read_b128 v[96:99], v105 offset:52224
  ds_read_b128 v[100:103], v105 offset:52736
  s_mov_b64 exec, -1
  v_cvt_pk_bf16_f32 v20, v4, v5
  v_exp_f32 v8, v8
  v_exp_f32 v9, v9
  v_cvt_pk_bf16_f32 v21, v6, v7
  v_exp_f32 v10, v10
  v_exp_f32 v11, v11
  v_cvt_pk_bf16_f32 v22, v8, v9
  v_exp_f32 v12, v12
  v_cvt_pk_bf16_f32 v23, v10, v11
  v_exp_f32 v13, v13
  v_exp_f32 v14, v14
  v_mfma_f32_32x32x16_bf16 v[64:79], v[88:91], v[20:23], v[64:79]
  s_barrier
  ds_read_b128 v[80:83], v104 offset:0
  v_exp_f32 v15, v15
  v_cvt_pk_bf16_f32 v24, v12, v13
  v_exp_f32 v16, v16
  v_exp_f32 v17, v17
  v_cvt_pk_bf16_f32 v25, v14, v15
  v_exp_f32 v18, v18
  v_exp_f32 v19, v19
  v_cvt_pk_bf16_f32 v26, v16, v17
  v_cvt_pk_bf16_f32 v27, v18, v19
  s_setprio 2
  s_waitcnt lgkmcnt(0)
  v_mfma_f32_32x32x16_bf16 v[4:19], v[80:83], v[28:31], v[48:63]
  v_exp_f32 v32, v32
  v_exp_f32 v33, v33
  v_exp_f32 v34, v34
  v_exp_f32 v35, v35
  v_mfma_f32_32x32x16_bf16 v[64:79], v[92:95], v[24:27], v[64:79]
  s_mov_b64 exec, s[54:55]
  ds_read_b128 v[88:91], v105 offset:0
  ds_read_b128 v[92:95], v105 offset:512
  s_mov_b64 exec, -1
  v_cvt_pk_bf16_f32 v20, v32, v33
  v_exp_f32 v36, v36
  v_exp_f32 v37, v37
  v_cvt_pk_bf16_f32 v21, v34, v35
  v_exp_f32 v38, v38
  v_exp_f32 v39, v39
  v_cvt_pk_bf16_f32 v22, v36, v37
  v_exp_f32 v40, v40
  v_cvt_pk_bf16_f32 v23, v38, v39
  v_exp_f32 v41, v41
  v_exp_f32 v42, v42
  v_mfma_f32_32x32x16_bf16 v[64:79], v[96:99], v[20:23], v[64:79]
  ds_read_b128 v[84:87], v104 offset:1024
  v_exp_f32 v43, v43
  v_cvt_pk_bf16_f32 v24, v40, v41
  v_exp_f32 v44, v44
  v_exp_f32 v45, v45
  v_cvt_pk_bf16_f32 v25, v42, v43
  v_exp_f32 v46, v46
  v_exp_f32 v47, v47
  v_cvt_pk_bf16_f32 v26, v44, v45
  v_cvt_pk_bf16_f32 v27, v46, v47
  s_sub_u32 s66, s66, 1
  s_cmp_lg_u32 s66, 0
  s_cbranch_scc1 L_attn_loop
  s_setprio 0
  s_nop 0
  v_mfma_f32_32x32x16_bf16 v[64:79], v[100:103], v[24:27], v[64:79]
  s_nop 11
  v_mov_b32 v107, v72
  s_nop 1
  v_permlane32_swap_b32 v72, v107
  s_nop 1
  v_rcp_f32 v107, v72
  s_cmp_lg_u32 s42, 0
  s_cbranch_scc1 L_chk_done_8
  s_mov_b32 s44, 0x5f800000
  v_cmp_nge_f32 vcc, s44, v72
  s_nop 1
  s_cbranch_vccz L_chk_done_8
  v_mov_b32 v106, 156804
  v_mov_b32 v4, 1
  ds_write_b32 v106, v4
L_chk_done_8:
  v_mul_f32 v64, v64, v107
  v_mul_f32 v65, v65, v107
  v_mul_f32 v66, v66, v107
  v_mul_f32 v67, v67, v107
  v_mul_f32 v68, v68, v107
  v_mul_f32 v69, v69, v107
  v_mul_f32 v70, v70, v107
  v_mul_f32 v71, v71, v107
  v_cvt_pk_bf16_f32 v20, v64, v65
  v_cvt_pk_bf16_f32 v21, v66, v67
  v_cvt_pk_bf16_f32 v22, v68, v69
  v_cvt_pk_bf16_f32 v23, v70, v71
  s_lshl_b32 s44, s38, 2
  s_and_b32 s45, s36, 3
  s_add_u32 s44, s44, s45
  s_lshl_b32 s44, s44, 5
  s_add_u32 s44, s44, s64
  s_lshl_b32 s44, s44, 10
  s_add_u32 s44, s44, 4456448
  buffer_store_dwordx4 v[20:23], v2, s[28:31], s44 offen sc1
  s_waitcnt vmcnt(0) lgkmcnt(0)
  s_barrier
  v_mov_b32 v106, 156804
  ds_read_b32 v107, v106
  s_waitcnt lgkmcnt(0)
  v_readfirstlane_b32 s44, v107
  s_nop 1
  s_cmp_eq_u32 s44, 0
  s_cbranch_scc1 L_attn_ok
  s_cmp_lg_u32 s42, 0
  s_cbranch_scc1 L_attn_ok
  s_mov_b32 s42, 1
  s_lshl_b32 s44, s64, 16
  s_add_u32 s44, s44, 262144
  s_mov_b32 s45, 64
  v_mov_b32 v106, 0xff800000
L_exact_max:
  buffer_load_dwordx4 v[80:83], v2, s[28:31], s44 offen sc1
  s_add_u32 s44, s44, 1024
  s_waitcnt vmcnt(0)
  v_mfma_f32_32x32x16_bf16 v[4:19], v[80:83], v[28:31], 0
  s_nop 11
  v_max3_f32 v106, v106, v4, v5
  v_max3_f32 v106, v106, v6, v7
  v_max3_f32 v106, v106, v8, v9
  v_max3_f32 v106, v106, v10, v11
  v_max3_f32 v106, v106, v12, v13
  v_max3_f32 v106, v106, v14, v15
  v_max3_f32 v106, v106, v16, v17
  v_max3_f32 v106, v106, v18, v19
  s_sub_u32 s45, s45, 1
  s_cmp_lg_u32 s45, 0
  s_cbranch_scc1 L_exact_max
  v_mov_b32 v107, v106
  s_nop 1
  v_permlane32_swap_b32 v106, v107
  v_max_f32 v106, v106, v107
  v_sub_f32 v48, 0, v106
  v_sub_f32 v49, 0, v106
  v_sub_f32 v50, 0, v106
  v_sub_f32 v51, 0, v106
  v_sub_f32 v52, 0, v106
  v_sub_f32 v53, 0, v106
  v_sub_f32 v54, 0, v106
  v_sub_f32 v55, 0, v106
  v_sub_f32 v56, 0, v106
  v_sub_f32 v57, 0, v106
  v_sub_f32 v58, 0, v106
  v_sub_f32 v59, 0, v106
  v_sub_f32 v60, 0, v106
  v_sub_f32 v61, 0, v106
  v_sub_f32 v62, 0, v106
  v_sub_f32 v63, 0, v106
  s_barrier
  s_branch L_attn_begin
L_attn_ok:
  s_lshl_b32 s70, s37, 2
  s_lshr_b32 s44, s38, 3
  s_lshl_b32 s44, s44, 1
  s_add_u32 s70, s70, s44
  s_and_b32 s44, s36, 1
  s_add_u32 s70, s70, s44
  s_and_b32 s71, s38, 7
  s_lshl_b32 s71, s71, 6
  s_bfe_u32 s44, s36, 0x10001
  s_lshl_b32 s44, s44, 5
  s_add_u32 s71, s71, s44
  s_lshr_b32 s44, s36, 2
  s_lshl_b32 s44, s44, 4
  s_add_u32 s71, s71, s44
  v_lshrrev_b32 v5, 5, v1
  v_lshlrev_b32 v5, 2, v5
  v_bfe_u32 v6, v1, 2, 2
  v_add_u32 v5, v5, v6
  v_lshlrev_b32 v4, 7, v5
  v_lshrrev_b32 v6, 1, v6
  s_bfe_u32 s44, s36, 0x10001
  v_xor_b32 v6, s44, v6
  v_lshl_add_u32 v4, v6, 6, v4
  s_lshr_b32 s44, s36, 2
  v_bfe_u32 v5, v1, 4, 1
  v_xor_b32 v5, s44, v5
  v_lshl_add_u32 v4, v5, 5, v4
  v_and_b32 v5, 3, v1
  v_lshl_add_u32 v4, v5, 3, v4
  v_and_b32 v5, 31, v1
  v_lshlrev_b32 v7, 10, v5
  v_lshrrev_b32 v5, 5, v1
  v_lshl_add_u32 v7, v5, 4, v7
  s_lshl_b32 s72, s70, 15
  s_lshl_b32 s44, s71, 1
  s_add_u32 s72, s72, s44
  buffer_load_dwordx4 v[8:11], v7, s[4:7], s72 offen
  s_and_b32 s44, s36, 1
  s_lshl_b32 s44, s44, 15
  s_lshr_b32 s45, s36, 2
  s_lshl_b32 s45, s45, 14
  s_add_u32 s44, s44, s45
  v_add_u32 v5, s44, v2
  s_lshl_b32 s44, s45, 1
  s_add_u32 s44, s44, 65536
  v_add_u32 v6, s44, v4
  s_lshr_b32 s45, s36, 2
  s_lshl_b32 s45, s45, 14
  s_and_b32 s47, s36, 3
  s_lshl_b32 s47, s47, 11
  s_add_u32 s45, s45, s47
  s_add_u32 s45, s45, 32768
  s_xor_b32 s46, s36, 4
  s_lshr_b32 s44, s46, 2
  s_lshl_b32 s44, s44, 14
  s_and_b32 s47, s46, 3
  s_lshl_b32 s47, s47, 11
  s_add_u32 s44, s44, s47
  s_add_u32 s44, s44, 32768
  v_add_u32 v52, s45, v2
  v_add_u32 v53, s44, v2
  s_lshl_b32 s62, s70, 15
  s_lshl_b32 s45, s71, 6
  s_add_u32 s62, s62, s45
  s_add_u32 s62, s62, 6553600
  v_and_b32 v56, 31, v1
  v_lshlrev_b32 v56, 3, v56
  s_and_b32 s44, s36, 1
  s_lshl_b32 s44, s44, 10
  s_add_u32 s44, s44, 90240
  v_add_u32 v54, s44, v56
  s_bfe_u32 s44, s36, 0x10001
  s_lshl_b32 s44, s44, 1
  s_lshr_b32 s45, s36, 2
  s_add_u32 s44, s44, s45
  s_lshl_b32 s44, s44, 8
  v_add_u32 v55, s44, v54
  s_lshl_b32 s63, s70, 3
  s_and_b32 s45, s38, 7
  s_add_u32 s63, s63, s45
  s_lshl_b32 s63, s63, 8
  s_add_u32 s63, s63, 14290944
  s_waitcnt vmcnt(0)
  v_permlane32_swap_b32 v8, v10
  v_permlane32_swap_b32 v9, v11
  s_barrier
  s_barrier
  ds_read_b128 v[28:31], v5 offset:0
  ds_read_b64_tr_b16 v[40:41], v6 offset:0
  ds_read_b64_tr_b16 v[42:43], v6 offset:1024
  ds_read_b128 v[32:35], v5 offset:1024
  ds_read_b64_tr_b16 v[44:45], v6 offset:2048
  ds_read_b64_tr_b16 v[46:47], v6 offset:3072
  s_waitcnt lgkmcnt(3)
  v_mfma_f32_32x32x16_bf16 v[12:27], v[40:43], v[28:31], 0
  ds_read_b128 v[36:39], v5 offset:2048
  ds_read_b64_tr_b16 v[48:49], v6 offset:4096
  ds_read_b64_tr_b16 v[50:51], v6 offset:5120
  s_waitcnt lgkmcnt(3)
  v_mfma_f32_32x32x16_bf16 v[12:27], v[44:47], v[32:35], v[12:27]
  ds_read_b128 v[28:31], v5 offset:3072
  ds_read_b64_tr_b16 v[40:41], v6 offset:6144
  ds_read_b64_tr_b16 v[42:43], v6 offset:7168
  s_waitcnt lgkmcnt(3)
  s_barrier
  v_mfma_f32_32x32x16_bf16 v[12:27], v[48:51], v[36:39], v[12:27]
  ds_read_b128 v[32:35], v5 offset:4096
  ds_read_b64_tr_b16 v[44:45], v6 offset:8192
  ds_read_b64_tr_b16 v[46:47], v6 offset:9216
  s_waitcnt lgkmcnt(3)
  v_mfma_f32_32x32x16_bf16 v[12:27], v[40:43], v[28:31], v[12:27]
  ds_read_b128 v[36:39], v5 offset:5120
  ds_read_b64_tr_b16 v[48:49], v6 offset:10240
  ds_read_b64_tr_b16 v[50:51], v6 offset:11264
  s_waitcnt lgkmcnt(3)
  v_mfma_f32_32x32x16_bf16 v[12:27], v[44:47], v[32:35], v[12:27]
  ds_read_b128 v[28:31], v5 offset:6144
  ds_read_b64_tr_b16 v[40:41], v6 offset:12288
  ds_read_b64_tr_b16 v[42:43], v6 offset:13312
  s_waitcnt lgkmcnt(3)
  v_mfma_f32_32x32x16_bf16 v[12:27], v[48:51], v[36:39], v[12:27]
  ds_read_b128 v[32:35], v5 offset:7168
  ds_read_b64_tr_b16 v[44:45], v6 offset:14336
  ds_read_b64_tr_b16 v[46:47], v6 offset:15360
  s_waitcnt lgkmcnt(3)
  s_barrier
  v_mfma_f32_32x32x16_bf16 v[12:27], v[40:43], v[28:31], v[12:27]
  ds_read_b128 v[36:39], v5 offset:8192
  ds_read_b64_tr_b16 v[48:49], v6 offset:16384
  ds_read_b64_tr_b16 v[50:51], v6 offset:17408
  s_waitcnt lgkmcnt(3)
  v_mfma_f32_32x32x16_bf16 v[12:27], v[44:47], v[32:35], v[12:27]
  ds_read_b128 v[28:31], v5 offset:9216
  ds_read_b64_tr_b16 v[40:41], v6 offset:18432
  ds_read_b64_tr_b16 v[42:43], v6 offset:19456
  s_waitcnt lgkmcnt(3)
  v_mfma_f32_32x32x16_bf16 v[12:27], v[48:51], v[36:39], v[12:27]
  ds_read_b128 v[32:35], v5 offset:10240
  ds_read_b64_tr_b16 v[44:45], v6 offset:20480
  ds_read_b64_tr_b16 v[46:47], v6 offset:21504
  s_waitcnt lgkmcnt(3)
  v_mfma_f32_32x32x16_bf16 v[12:27], v[40:43], v[28:31], v[12:27]
  ds_read_b128 v[36:39], v5 offset:11264
  ds_read_b64_tr_b16 v[48:49], v6 offset:22528
  ds_read_b64_tr_b16 v[50:51], v6 offset:23552
  s_waitcnt lgkmcnt(3)
  s_barrier
  v_mfma_f32_32x32x16_bf16 v[12:27], v[44:47], v[32:35], v[12:27]
  ds_read_b128 v[28:31], v5 offset:12288
  ds_read_b64_tr_b16 v[40:41], v6 offset:24576
  ds_read_b64_tr_b16 v[42:43], v6 offset:25600
  s_waitcnt lgkmcnt(3)
  v_mfma_f32_32x32x16_bf16 v[12:27], v[48:51], v[36:39], v[12:27]
  ds_read_b128 v[32:35], v5 offset:13312
  ds_read_b64_tr_b16 v[44:45], v6 offset:26624
  ds_read_b64_tr_b16 v[46:47], v6 offset:27648
  s_waitcnt lgkmcnt(3)
  v_mfma_f32_32x32x16_bf16 v[12:27], v[40:43], v[28:31], v[12:27]
  ds_read_b128 v[36:39], v5 offset:14336
  ds_read_b64_tr_b16 v[48:49], v6 offset:28672
  ds_read_b64_tr_b16 v[50:51], v6 offset:29696
  s_waitcnt lgkmcnt(3)
  v_mfma_f32_32x32x16_bf16 v[12:27], v[44:47], v[32:35], v[12:27]
  ds_read_b128 v[28:31], v5 offset:15360
  ds_read_b64_tr_b16 v[40:41], v6 offset:30720
  ds_read_b64_tr_b16 v[42:43], v6 offset:31744
  s_waitcnt lgkmcnt(3)
  v_mfma_f32_32x32x16_bf16 v[12:27], v[48:51], v[36:39], v[12:27]
  s_waitcnt lgkmcnt(0)
  v_mfma_f32_32x32x16_bf16 v[12:27], v[40:43], v[28:31], v[12:27]
  s_nop 11
  ds_write_b128 v52, v[20:23]
  ds_write_b128 v52, v[24:27] offset:1024
  s_waitcnt lgkmcnt(0)
  s_barrier
  ds_read_b128 v[60:63], v53
  ds_read_b128 v[64:67], v53 offset:1024
  s_waitcnt lgkmcnt(0)
  v_add_f32 v12, v12, v60
  v_add_f32 v13, v13, v61
  v_add_f32 v14, v14, v62
  v_add_f32 v15, v15, v63
  v_add_f32 v16, v16, v64
  v_add_f32 v17, v17, v65
  v_add_f32 v18, v18, v66
  v_add_f32 v19, v19, v67
  v_lshlrev_b32 v57, 16, v8
  v_add_f32 v12, v12, v57
  v_and_b32 v57, 0xffff0000, v8
  v_add_f32 v13, v13, v57
  v_lshlrev_b32 v57, 16, v9
  v_add_f32 v14, v14, v57
  v_and_b32 v57, 0xffff0000, v9
  v_add_f32 v15, v15, v57
  v_lshlrev_b32 v57, 16, v10
  v_add_f32 v16, v16, v57
  v_and_b32 v57, 0xffff0000, v10
  v_add_f32 v17, v17, v57
  v_lshlrev_b32 v57, 16, v11
  v_add_f32 v18, v18, v57
  v_and_b32 v57, 0xffff0000, v11
  v_add_f32 v19, v19, v57
  v_cvt_pk_bf16_f32 v60, v12, v13
  v_cvt_pk_bf16_f32 v61, v14, v15
  v_cvt_pk_bf16_f32 v62, v16, v17
  v_cvt_pk_bf16_f32 v63, v18, v19
  s_cmp_eq_u32 s39, 0
  s_cbranch_scc1 L_st_slow_14
  buffer_store_dwordx4 v[60:63], v2, s[28:31], s62 offen
  s_branch L_st_done_15
L_st_slow_14:
  buffer_store_dwordx4 v[60:63], v2, s[28:31], s62 offen sc1
L_st_done_15:
  v_lshlrev_b32 v57, 16, v60
  v_and_b32 v64, 0xffff0000, v60
  v_add_f32 v58, v57, v64
  v_mul_f32 v59, v57, v57
  v_fmac_f32 v59, v64, v64
  v_lshlrev_b32 v57, 16, v61
  v_and_b32 v64, 0xffff0000, v61
  v_add_f32 v58, v58, v57
  v_fmac_f32 v59, v57, v57
  v_add_f32 v58, v58, v64
  v_fmac_f32 v59, v64, v64
  v_lshlrev_b32 v57, 16, v62
  v_and_b32 v64, 0xffff0000, v62
  v_add_f32 v58, v58, v57
  v_fmac_f32 v59, v57, v57
  v_add_f32 v58, v58, v64
  v_fmac_f32 v59, v64, v64
  v_lshlrev_b32 v57, 16, v63
  v_and_b32 v64, 0xffff0000, v63
  v_add_f32 v58, v58, v57
  v_fmac_f32 v59, v57, v57
  v_add_f32 v58, v58, v64
  v_fmac_f32 v59, v64, v64
  v_mov_b32 v57, v58
  s_nop 1
  v_permlane32_swap_b32 v58, v57
  v_add_f32 v58, v58, v57
  v_mov_b32 v57, v59
  s_nop 1
  v_permlane32_swap_b32 v59, v57
  v_add_f32 v59, v59, v57
  ds_write_b64 v55, v[58:59]
  s_waitcnt lgkmcnt(0)
  s_barrier
  s_cmp_ge_u32 s36, 2
  s_cbranch_scc1 L_st_skip_16
  ds_read_b64 v[68:69], v54 offset:0
  ds_read_b64 v[70:71], v54 offset:256
  ds_read_b64 v[72:73], v54 offset:512
  ds_read_b64 v[74:75], v54 offset:768
  s_waitcnt lgkmcnt(0)
  v_add_f32 v68, v68, v70
  v_add_f32 v72, v72, v74
  v_add_f32 v68, v68, v72
  v_add_f32 v69, v69, v71
  v_add_f32 v73, v73, v75
  v_add_f32 v69, v69, v73
  s_cmp_eq_u32 s39, 0
  s_cbranch_scc1 L_st_slow_17
  buffer_store_dwordx2 v[68:69], v56, s[28:31], s63 offen
  s_branch L_st_done_18
L_st_slow_17:
  buffer_store_dwordx2 v[68:69], v56, s[28:31], s63 offen sc1
L_st_done_18:
L_st_skip_16:
  s_waitcnt vmcnt(0)
  s_barrier
  s_mul_i32 s68, s38, 6
  s_lshl_b32 s44, s38, 2
  s_add_u32 s44, s44, 22
  s_min_u32 s68, s68, s44
  s_lshr_b32 s45, s36, 2
  s_mul_i32 s60, s45, 3
  s_lshl_b32 s61, s45, 1
  s_add_u32 s61, s61, s36
  v_lshrrev_b32 v5, 5, v1
  v_lshlrev_b32 v5, 2, v5
  v_bfe_u32 v6, v1, 2, 2
  v_add_u32 v5, v5, v6
  v_mul_u32_u24 v5, 192, v5
  v_and_b32 v6, 3, v1
  v_lshl_add_u32 v5, v6, 3, v5
  v_bfe_u32 v6, v1, 4, 1
  v_mul_u32_u24 v6, 12320, v6
  v_add_u32 v5, v5, v6
  s_lshl_b32 s46, s60, 5
  v_add_u32 v5, s46, v5
  s_and_b32 s44, s36, 3
  s_lshl_b32 s44, s44, 12
  s_add_u32 s44, s44, 73856
  v_add_u32 v6, s44, v2
  s_add_u32 s44, s61, 0
  s_and_b32 s44, s44, 3
  s_mul_i32 s45, s44, 3072
  s_lshl_b32 s44, s44, 10
  v_add_u32 v8, s45, v5
  v_add_u32 v16, s44, v6
  v_add_u32 v12, 131072, v8
  s_add_u32 s44, s61, 1
  s_and_b32 s44, s44, 3
  s_mul_i32 s45, s44, 3072
  s_lshl_b32 s44, s44, 10
  v_add_u32 v9, s45, v5
  v_add_u32 v17, s44, v6
  v_add_u32 v13, 131072, v9
  s_add_u32 s44, s61, 2
  s_and_b32 s44, s44, 3
  s_mul_i32 s45, s44, 3072
  s_lshl_b32 s44, s44, 10
  v_add_u32 v10, s45, v5
  v_add_u32 v18, s44, v6
  v_add_u32 v14, 131072, v10
  s_add_u32 s44, s61, 3
  s_and_b32 s44, s44, 3
  s_mul_i32 s45, s44, 3072
  s_lshl_b32 s44, s44, 10
  v_add_u32 v11, s45, v5
  v_add_u32 v19, s44, v6
  v_add_u32 v15, 131072, v11
  v_and_b32 v116, 15, v1
  v_bfe_u32 v5, v1, 4, 1
  v_cmp_eq_u32 vcc, v116, v5
  v_mov_b32 v5, 0x3f803f80
  s_nop 0
  v_cndmask_b32 v116, 0, v5, vcc
  v_mov_b32 v117, v116
  v_mov_b32 v118, v116
  v_mov_b32 v119, v116
  v_and_b32 v128, 1, v1
  v_lshlrev_b32 v128, 6, v128
  v_lshrrev_b32 v5, 4, v1
  v_lshl_add_u32 v128, v5, 4, v128
  s_mul_i32 s44, s36, 384
  s_add_u32 s45, s44, 106624
  v_add_u32 v128, s45, v128
  v_and_b32 v6, 31, v1
  v_lshlrev_b32 v6, 2, v6
  s_add_u32 s44, s44, 111744
  v_add_u32 v129, s44, v6
  v_lshrrev_b32 v131, 5, v1
  v_lshlrev_b32 v131, 4, v131
  v_add_u32 v131, s44, v131
  s_lshr_b32 s45, s36, 2
  s_mul_i32 s45, s45, 1536
  s_add_u32 s45, s45, 106624
  v_add_u32 v130, s45, v6
  s_lshl_b32 s44, s37, 2
  s_and_b32 s45, s36, 3
  s_add_u32 s44, s44, s45
  s_mul_i32 s44, s44, 86
  s_add_u32 s44, s44, s68
  s_add_u32 s44, s44, s60
  s_lshl_b32 s63, s44, 10
  s_add_u32 s63, s63, 8650752
  s_cmp_lt_u32 s38, 11
  s_cselect_b32 s65, 6, 4
  v_and_b32 v138, 31, v1
  v_lshlrev_b32 v138, 3, v138
  v_lshrrev_b32 v6, 5, v1
  v_lshl_add_u32 v138, v6, 10, v138
  s_lshl_b32 s67, s37, 2
  s_and_b32 s45, s36, 3
  s_add_u32 s67, s67, s45
  s_lshl_b32 s67, s67, 11
  s_add_u32 s67, s67, 14290944
  s_barrier
  buffer_load_dwordx2 v[120:121], v138, s[28:31], s67 offen offset:0 sc1
  buffer_load_dwordx2 v[122:123], v138, s[28:31], s67 offen offset:256 sc1
  buffer_load_dwordx2 v[124:125], v138, s[28:31], s67 offen offset:512 sc1
  buffer_load_dwordx2 v[126:127], v138, s[28:31], s67 offen offset:768 sc1
  s_barrier
  ds_read_b128 v[52:55], v16 offset:0
  ds_read_b64_tr_b16 v[80:81], v12 offset:0
  ds_read_b64_tr_b16 v[82:83], v12 offset:1536
  ds_read_b64_tr_b16 v[84:85], v12 offset:32
  ds_read_b64_tr_b16 v[86:87], v12 offset:1568
  ds_read_b64_tr_b16 v[88:89], v12 offset:64
  ds_read_b64_tr_b16 v[90:91], v12 offset:1600
  s_setprio 1
  s_waitcnt lgkmcnt(0)
  v_mfma_f32_32x32x16_bf16 v[20:35], v[80:83], v[52:55], 0
  v_mfma_f32_16x16x32_bf16 v[104:107], v[80:83], v[116:119], 0
  ds_read_b128 v[56:59], v17 offset:0
  ds_read_b64_tr_b16 v[92:93], v13 offset:0
  ds_read_b64_tr_b16 v[94:95], v13 offset:1536
  v_mfma_f32_32x32x16_bf16 v[36:51], v[84:87], v[52:55], 0
  ds_read_b64_tr_b16 v[96:97], v13 offset:32
  ds_read_b64_tr_b16 v[98:99], v13 offset:1568
  ds_read_b64_tr_b16 v[100:101], v13 offset:64
  ds_read_b64_tr_b16 v[102:103], v13 offset:1600
  v_mfma_f32_32x32x16_bf16 v[64:79], v[88:91], v[52:55], 0
  s_setprio 0
  s_waitcnt lgkmcnt(0)
  v_mfma_f32_32x32x16_bf16 v[20:35], v[92:95], v[56:59], v[20:35]
  ds_read_b128 v[52:55], v18 offset:0
  ds_read_b64_tr_b16 v[80:81], v14 offset:0
  ds_read_b64_tr_b16 v[82:83], v14 offset:1536
  v_mfma_f32_32x32x16_bf16 v[36:51], v[96:99], v[56:59], v[36:51]
  v_mfma_f32_16x16x32_bf16 v[108:111], v[96:99], v[116:119], 0
  ds_read_b64_tr_b16 v[84:85], v14 offset:32
  ds_read_b64_tr_b16 v[86:87], v14 offset:1568
  ds_read_b64_tr_b16 v[88:89], v14 offset:64
  ds_read_b64_tr_b16 v[90:91], v14 offset:1600
  v_mfma_f32_32x32x16_bf16 v[64:79], v[100:103], v[56:59], v[64:79]
  s_setprio 0
  s_waitcnt lgkmcnt(0)
  v_mfma_f32_32x32x16_bf16 v[20:35], v[80:83], v[52:55], v[20:35]
  ds_read_b128 v[56:59], v19 offset:0
  ds_read_b64_tr_b16 v[92:93], v15 offset:0
  ds_read_b64_tr_b16 v[94:95], v15 offset:1536
  v_mfma_f32_32x32x16_bf16 v[36:51], v[84:87], v[52:55], v[36:51]
  ds_read_b64_tr_b16 v[96:97], v15 offset:32
  ds_read_b64_tr_b16 v[98:99], v15 offset:1568
  ds_read_b64_tr_b16 v[100:101], v15 offset:64
  ds_read_b64_tr_b16 v[102:103], v15 offset:1600
  v_mfma_f32_32x32x16_bf16 v[64:79], v[88:91], v[52:55], v[64:79]
  v_mfma_f32_16x16x32_bf16 v[112:115], v[88:91], v[116:119], 0
  s_setprio 2
  s_waitcnt lgkmcnt(0)
  s_barrier
  v_mfma_f32_32x32x16_bf16 v[20:35], v[92:95], v[56:59], v[20:35]
  ds_read_b128 v[52:55], v16 offset:16384
  ds_read_b64_tr_b16 v[80:81], v8 offset:0
  ds_read_b64_tr_b16 v[82:83], v8 offset:1536
  v_mfma_f32_32x32x16_bf16 v[36:51], v[96:99], v[56:59], v[36:51]
  ds_read_b64_tr_b16 v[84:85], v8 offset:32
  ds_read_b64_tr_b16 v[86:87], v8 offset:1568
  ds_read_b64_tr_b16 v[88:89], v8 offset:64
  ds_read_b64_tr_b16 v[90:91], v8 offset:1600
  v_mfma_f32_32x32x16_bf16 v[64:79], v[100:103], v[56:59], v[64:79]
  s_setprio 1
  s_waitcnt lgkmcnt(0)
  v_mfma_f32_32x32x16_bf16 v[20:35], v[80:83], v[52:55], v[20:35]
  v_mfma_f32_16x16x32_bf16 v[104:107], v[80:83], v[116:119], v[104:107]
  ds_read_b128 v[56:59], v17 offset:16384
  ds_read_b64_tr_b16 v[92:93], v9 offset:0
  ds_read_b64_tr_b16 v[94:95], v9 offset:1536
  v_mfma_f32_32x32x16_bf16 v[36:51], v[84:87], v[52:55], v[36:51]
  ds_read_b64_tr_b16 v[96:97], v9 offset:32
  ds_read_b64_tr_b16 v[98:99], v9 offset:1568
  ds_read_b64_tr_b16 v[100:101], v9 offset:64
  ds_read_b64_tr_b16 v[102:103], v9 offset:1600
  v_mfma_f32_32x32x16_bf16 v[64:79], v[88:91], v[52:55], v[64:79]
  s_setprio 0
  s_waitcnt lgkmcnt(0)
  v_mfma_f32_32x32x16_bf16 v[20:35], v[92:95], v[56:59], v[20:35]
  ds_read_b128 v[52:55], v18 offset:16384
  ds_read_b64_tr_b16 v[80:81], v10 offset:0
  ds_read_b64_tr_b16 v[82:83], v10 offset:1536
  v_mfma_f32_32x32x16_bf16 v[36:51], v[96:99], v[56:59], v[36:51]
  v_mfma_f32_16x16x32_bf16 v[108:111], v[96:99], v[116:119], v[108:111]
  ds_read_b64_tr_b16 v[84:85], v10 offset:32
  ds_read_b64_tr_b16 v[86:87], v10 offset:1568
  ds_read_b64_tr_b16 v[88:89], v10 offset:64
  ds_read_b64_tr_b16 v[90:91], v10 offset:1600
  v_mfma_f32_32x32x16_bf16 v[64:79], v[100:103], v[56:59], v[64:79]
  s_setprio 0
  s_waitcnt lgkmcnt(0)
  v_mfma_f32_32x32x16_bf16 v[20:35], v[80:83], v[52:55], v[20:35]
  ds_read_b128 v[56:59], v19 offset:16384
  ds_read_b64_tr_b16 v[92:93], v11 offset:0
  ds_read_b64_tr_b16 v[94:95], v11 offset:1536
  v_mfma_f32_32x32x16_bf16 v[36:51], v[84:87], v[52:55], v[36:51]
  ds_read_b64_tr_b16 v[96:97], v11 offset:32
  ds_read_b64_tr_b16 v[98:99], v11 offset:1568
  ds_read_b64_tr_b16 v[100:101], v11 offset:64
  ds_read_b64_tr_b16 v[102:103], v11 offset:1600
  v_mfma_f32_32x32x16_bf16 v[64:79], v[88:91], v[52:55], v[64:79]
  v_mfma_f32_16x16x32_bf16 v[112:115], v[88:91], v[116:119], v[112:115]
  s_setprio 2
  s_waitcnt lgkmcnt(0)
  s_barrier
  v_mfma_f32_32x32x16_bf16 v[20:35], v[92:95], v[56:59], v[20:35]
  ds_read_b128 v[52:55], v16 offset:32768
  ds_read_b64_tr_b16 v[80:81], v8 offset:24608
  ds_read_b64_tr_b16 v[82:83], v8 offset:26144
  v_mfma_f32_32x32x16_bf16 v[36:51], v[96:99], v[56:59], v[36:51]
  ds_read_b64_tr_b16 v[84:85], v8 offset:24640
  ds_read_b64_tr_b16 v[86:87], v8 offset:26176
  ds_read_b64_tr_b16 v[88:89], v8 offset:24672
  ds_read_b64_tr_b16 v[90:91], v8 offset:26208
  v_mfma_f32_32x32x16_bf16 v[64:79], v[100:103], v[56:59], v[64:79]
  s_setprio 1
  s_waitcnt lgkmcnt(0)
  v_mfma_f32_32x32x16_bf16 v[20:35], v[80:83], v[52:55], v[20:35]
  v_mfma_f32_16x16x32_bf16 v[104:107], v[80:83], v[116:119], v[104:107]
  ds_read_b128 v[56:59], v17 offset:32768
  ds_read_b64_tr_b16 v[92:93], v9 offset:24608
  ds_read_b64_tr_b16 v[94:95], v9 offset:26144
  v_mfma_f32_32x32x16_bf16 v[36:51], v[84:87], v[52:55], v[36:51]
  ds_read_b64_tr_b16 v[96:97], v9 offset:24640
  ds_read_b64_tr_b16 v[98:99], v9 offset:26176
  ds_read_b64_tr_b16 v[100:101], v9 offset:24672
  ds_read_b64_tr_b16 v[102:103], v9 offset:26208
  v_mfma_f32_32x32x16_bf16 v[64:79], v[88:91], v[52:55], v[64:79]
  s_setprio 0
  s_waitcnt lgkmcnt(0)
  v_mfma_f32_32x32x16_bf16 v[20:35], v[92:95], v[56:59], v[20:35]
  ds_read_b128 v[52:55], v18 offset:32768
  ds_read_b64_tr_b16 v[80:81], v10 offset:24608
  ds_read_b64_tr_b16 v[82:83], v10 offset:26144
  v_mfma_f32_32x32x16_bf16 v[36:51], v[96:99], v[56:59], v[36:51]
  v_mfma_f32_16x16x32_bf16 v[108:111], v[96:99], v[116:119], v[108:111]
  ds_read_b64_tr_b16 v[84:85], v10 offset:24640
  ds_read_b64_tr_b16 v[86:87], v10 offset:26176
  ds_read_b64_tr_b16 v[88:89], v10 offset:24672
  ds_read_b64_tr_b16 v[90:91], v10 offset:26208
  v_mfma_f32_32x32x16_bf16 v[64:79], v[100:103], v[56:59], v[64:79]
  s_waitcnt vmcnt(0)
  v_add_f32 v120, v120, v122
  v_add_f32 v124, v124, v126
  v_add_f32 v120, v120, v124
  v_add_f32 v121, v121, v123
  v_add_f32 v125, v125, v127
  v_add_f32 v121, v121, v125
  v_mov_b32 v5, v120
  s_nop 1
  v_permlane32_swap_b32 v120, v5
  v_add_f32 v120, v120, v5
  v_mov_b32 v5, v121
  s_nop 1
  v_permlane32_swap_b32 v121, v5
  v_add_f32 v121, v121, v5
  v_mul_f32 v132, 0xbb000000, v120
  v_mul_f32 v5, v132, v132
  v_mov_b32 v136, 0x3b000000
  v_fma_f32 v136, v121, v136, -v5
  v_max_f32 v136, 0, v136
  v_add_f32 v136, 0x3727c5ac, v136
  v_rsq_f32 v134, v136
  s_nop 0
  v_mul_f32 v134, 0xbfb8aa3b, v134
  s_setprio 0
  s_waitcnt lgkmcnt(0)
  v_mfma_f32_32x32x16_bf16 v[20:35], v[80:83], v[52:55], v[20:35]
  ds_read_b128 v[56:59], v19 offset:32768
  ds_read_b64_tr_b16 v[92:93], v11 offset:24608
  ds_read_b64_tr_b16 v[94:95], v11 offset:26144
  v_mfma_f32_32x32x16_bf16 v[36:51], v[84:87], v[52:55], v[36:51]
  ds_read_b64_tr_b16 v[96:97], v11 offset:24640
  ds_read_b64_tr_b16 v[98:99], v11 offset:26176
  ds_read_b64_tr_b16 v[100:101], v11 offset:24672
  ds_read_b64_tr_b16 v[102:103], v11 offset:26208
  v_mfma_f32_32x32x16_bf16 v[64:79], v[88:91], v[52:55], v[64:79]
  v_mfma_f32_16x16x32_bf16 v[112:115], v[88:91], v[116:119], v[112:115]
  s_setprio 2
  s_waitcnt lgkmcnt(0)
  s_barrier
  v_mfma_f32_32x32x16_bf16 v[20:35], v[92:95], v[56:59], v[20:35]
  ds_read_b128 v[52:55], v16 offset:0
  ds_read_b64_tr_b16 v[80:81], v8 offset:49216
  ds_read_b64_tr_b16 v[82:83], v8 offset:50752
  v_mfma_f32_32x32x16_bf16 v[36:51], v[96:99], v[56:59], v[36:51]
  ds_read_b64_tr_b16 v[84:85], v8 offset:49248
  ds_read_b64_tr_b16 v[86:87], v8 offset:50784
  ds_read_b64_tr_b16 v[88:89], v8 offset:49280
  ds_read_b64_tr_b16 v[90:91], v8 offset:50816
  v_mfma_f32_32x32x16_bf16 v[64:79], v[100:103], v[56:59], v[64:79]
  s_setprio 1
  s_waitcnt lgkmcnt(0)
  v_mfma_f32_32x32x16_bf16 v[20:35], v[80:83], v[52:55], v[20:35]
  v_mfma_f32_16x16x32_bf16 v[104:107], v[80:83], v[116:119], v[104:107]
  ds_read_b128 v[56:59], v17 offset:0
  ds_read_b64_tr_b16 v[92:93], v9 offset:49216
  ds_read_b64_tr_b16 v[94:95], v9 offset:50752
  v_mfma_f32_32x32x16_bf16 v[36:51], v[84:87], v[52:55], v[36:51]
  ds_read_b64_tr_b16 v[96:97], v9 offset:49248
  ds_read_b64_tr_b16 v[98:99], v9 offset:50784
  ds_read_b64_tr_b16 v[100:101], v9 offset:49280
  ds_read_b64_tr_b16 v[102:103], v9 offset:50816
  v_mfma_f32_32x32x16_bf16 v[64:79], v[88:91], v[52:55], v[64:79]
  s_setprio 0
  s_waitcnt lgkmcnt(0)
  v_mfma_f32_32x32x16_bf16 v[20:35], v[92:95], v[56:59], v[20:35]
  ds_read_b128 v[52:55], v18 offset:0
  ds_read_b64_tr_b16 v[80:81], v10 offset:49216
  ds_read_b64_tr_b16 v[82:83], v10 offset:50752
  v_mfma_f32_32x32x16_bf16 v[36:51], v[96:99], v[56:59], v[36:51]
  v_mfma_f32_16x16x32_bf16 v[108:111], v[96:99], v[116:119], v[108:111]
  ds_read_b64_tr_b16 v[84:85], v10 offset:49248
  ds_read_b64_tr_b16 v[86:87], v10 offset:50784
  ds_read_b64_tr_b16 v[88:89], v10 offset:49280
  ds_read_b64_tr_b16 v[90:91], v10 offset:50816
  v_mfma_f32_32x32x16_bf16 v[64:79], v[100:103], v[56:59], v[64:79]
  s_setprio 0
  s_waitcnt lgkmcnt(0)
  v_mfma_f32_32x32x16_bf16 v[20:35], v[80:83], v[52:55], v[20:35]
  ds_read_b128 v[56:59], v19 offset:0
  ds_read_b64_tr_b16 v[92:93], v11 offset:49216
  ds_read_b64_tr_b16 v[94:95], v11 offset:50752
  v_mfma_f32_32x32x16_bf16 v[36:51], v[84:87], v[52:55], v[36:51]
  ds_read_b64_tr_b16 v[96:97], v11 offset:49248
  ds_read_b64_tr_b16 v[98:99], v11 offset:50784
  ds_read_b64_tr_b16 v[100:101], v11 offset:49280
  ds_read_b64_tr_b16 v[102:103], v11 offset:50816
  v_mfma_f32_32x32x16_bf16 v[64:79], v[88:91], v[52:55], v[64:79]
  v_mfma_f32_16x16x32_bf16 v[112:115], v[88:91], v[116:119], v[112:115]
  s_setprio 2
  s_waitcnt lgkmcnt(0)
  s_barrier
  v_mfma_f32_32x32x16_bf16 v[20:35], v[92:95], v[56:59], v[20:35]
  ds_read_b128 v[52:55], v16 offset:16384
  ds_read_b64_tr_b16 v[80:81], v12 offset:0
  ds_read_b64_tr_b16 v[82:83], v12 offset:1536
  v_mfma_f32_32x32x16_bf16 v[36:51], v[96:99], v[56:59], v[36:51]
  ds_read_b64_tr_b16 v[84:85], v12 offset:32
  ds_read_b64_tr_b16 v[86:87], v12 offset:1568
  ds_read_b64_tr_b16 v[88:89], v12 offset:64
  ds_read_b64_tr_b16 v[90:91], v12 offset:1600
  v_mfma_f32_32x32x16_bf16 v[64:79], v[100:103], v[56:59], v[64:79]
  s_setprio 1
  s_waitcnt lgkmcnt(0)
  v_mfma_f32_32x32x16_bf16 v[20:35], v[80:83], v[52:55], v[20:35]
  v_mfma_f32_16x16x32_bf16 v[104:107], v[80:83], v[116:119], v[104:107]
  ds_read_b128 v[56:59], v17 offset:16384
  ds_read_b64_tr_b16 v[92:93], v13 offset:0
  ds_read_b64_tr_b16 v[94:95], v13 offset:1536
  v_mfma_f32_32x32x16_bf16 v[36:51], v[84:87], v[52:55], v[36:51]
  ds_read_b64_tr_b16 v[96:97], v13 offset:32
  ds_read_b64_tr_b16 v[98:99], v13 offset:1568
  ds_read_b64_tr_b16 v[100:101], v13 offset:64
  ds_read_b64_tr_b16 v[102:103], v13 offset:1600
  v_mfma_f32_32x32x16_bf16 v[64:79], v[88:91], v[52:55], v[64:79]
  s_setprio 0
  s_waitcnt lgkmcnt(0)
  v_mfma_f32_32x32x16_bf16 v[20:35], v[92:95], v[56:59], v[20:35]
  ds_read_b128 v[52:55], v18 offset:16384
  ds_read_b64_tr_b16 v[80:81], v14 offset:0
  ds_read_b64_tr_b16 v[82:83], v14 offset:1536
  v_mfma_f32_32x32x16_bf16 v[36:51], v[96:99], v[56:59], v[36:51]
  v_mfma_f32_16x16x32_bf16 v[108:111], v[96:99], v[116:119], v[108:111]
  ds_read_b64_tr_b16 v[84:85], v14 offset:32
  ds_read_b64_tr_b16 v[86:87], v14 offset:1568
  ds_read_b64_tr_b16 v[88:89], v14 offset:64
  ds_read_b64_tr_b16 v[90:91], v14 offset:1600
  v_mfma_f32_32x32x16_bf16 v[64:79], v[100:103], v[56:59], v[64:79]
  s_setprio 0
  s_waitcnt lgkmcnt(0)
  v_mfma_f32_32x32x16_bf16 v[20:35], v[80:83], v[52:55], v[20:35]
  ds_read_b128 v[56:59], v19 offset:16384
  ds_read_b64_tr_b16 v[92:93], v15 offset:0
  ds_read_b64_tr_b16 v[94:95], v15 offset:1536
  v_mfma_f32_32x32x16_bf16 v[36:51], v[84:87], v[52:55], v[36:51]
  ds_read_b64_tr_b16 v[96:97], v15 offset:32
  ds_read_b64_tr_b16 v[98:99], v15 offset:1568
  ds_read_b64_tr_b16 v[100:101], v15 offset:64
  ds_read_b64_tr_b16 v[102:103], v15 offset:1600
  v_mfma_f32_32x32x16_bf16 v[64:79], v[88:91], v[52:55], v[64:79]
  v_mfma_f32_16x16x32_bf16 v[112:115], v[88:91], v[116:119], v[112:115]
  s_setprio 2
  s_waitcnt lgkmcnt(0)
  s_barrier
  v_mfma_f32_32x32x16_bf16 v[20:35], v[92:95], v[56:59], v[20:35]
  ds_read_b128 v[52:55], v16 offset:32768
  ds_read_b64_tr_b16 v[80:81], v8 offset:0
  ds_read_b64_tr_b16 v[82:83], v8 offset:1536
  v_mfma_f32_32x32x16_bf16 v[36:51], v[96:99], v[56:59], v[36:51]
  ds_read_b64_tr_b16 v[84:85], v8 offset:32
  ds_read_b64_tr_b16 v[86:87], v8 offset:1568
  ds_read_b64_tr_b16 v[88:89], v8 offset:64
  ds_read_b64_tr_b16 v[90:91], v8 offset:1600
  v_mfma_f32_32x32x16_bf16 v[64:79], v[100:103], v[56:59], v[64:79]
  s_setprio 1
  s_waitcnt lgkmcnt(0)
  v_mfma_f32_32x32x16_bf16 v[20:35], v[80:83], v[52:55], v[20:35]
  v_mfma_f32_16x16x32_bf16 v[104:107], v[80:83], v[116:119], v[104:107]
  ds_read_b128 v[56:59], v17 offset:32768
  ds_read_b64_tr_b16 v[92:93], v9 offset:0
  ds_read_b64_tr_b16 v[94:95], v9 offset:1536
  v_mfma_f32_32x32x16_bf16 v[36:51], v[84:87], v[52:55], v[36:51]
  ds_read_b64_tr_b16 v[96:97], v9 offset:32
  ds_read_b64_tr_b16 v[98:99], v9 offset:1568
  ds_read_b64_tr_b16 v[100:101], v9 offset:64
  ds_read_b64_tr_b16 v[102:103], v9 offset:1600
  v_mfma_f32_32x32x16_bf16 v[64:79], v[88:91], v[52:55], v[64:79]
  s_setprio 0
  s_waitcnt lgkmcnt(0)
  v_mfma_f32_32x32x16_bf16 v[20:35], v[92:95], v[56:59], v[20:35]
  ds_read_b128 v[52:55], v18 offset:32768
  ds_read_b64_tr_b16 v[80:81], v10 offset:0
  ds_read_b64_tr_b16 v[82:83], v10 offset:1536
  v_mfma_f32_32x32x16_bf16 v[36:51], v[96:99], v[56:59], v[36:51]
  v_mfma_f32_16x16x32_bf16 v[108:111], v[96:99], v[116:119], v[108:111]
  ds_read_b64_tr_b16 v[84:85], v10 offset:32
  ds_read_b64_tr_b16 v[86:87], v10 offset:1568
  ds_read_b64_tr_b16 v[88:89], v10 offset:64
  ds_read_b64_tr_b16 v[90:91], v10 offset:1600
  v_mfma_f32_32x32x16_bf16 v[64:79], v[100:103], v[56:59], v[64:79]
  s_setprio 0
  s_waitcnt lgkmcnt(0)
  v_mfma_f32_32x32x16_bf16 v[20:35], v[80:83], v[52:55], v[20:35]
  ds_read_b128 v[56:59], v19 offset:32768
  ds_read_b64_tr_b16 v[92:93], v11 offset:0
  ds_read_b64_tr_b16 v[94:95], v11 offset:1536
  v_mfma_f32_32x32x16_bf16 v[36:51], v[84:87], v[52:55], v[36:51]
  ds_read_b64_tr_b16 v[96:97], v11 offset:32
  ds_read_b64_tr_b16 v[98:99], v11 offset:1568
  ds_read_b64_tr_b16 v[100:101], v11 offset:64
  ds_read_b64_tr_b16 v[102:103], v11 offset:1600
  v_mfma_f32_32x32x16_bf16 v[64:79], v[88:91], v[52:55], v[64:79]
  v_mfma_f32_16x16x32_bf16 v[112:115], v[88:91], v[116:119], v[112:115]
  s_setprio 2
  s_waitcnt lgkmcnt(0)
  s_barrier
  v_mfma_f32_32x32x16_bf16 v[20:35], v[92:95], v[56:59], v[20:35]
  ds_read_b128 v[52:55], v16 offset:0
  ds_read_b64_tr_b16 v[80:81], v8 offset:24608
  ds_read_b64_tr_b16 v[82:83], v8 offset:26144
  v_mfma_f32_32x32x16_bf16 v[36:51], v[96:99], v[56:59], v[36:51]
  ds_read_b64_tr_b16 v[84:85], v8 offset:24640
  ds_read_b64_tr_b16 v[86:87], v8 offset:26176
  ds_read_b64_tr_b16 v[88:89], v8 offset:24672
  ds_read_b64_tr_b16 v[90:91], v8 offset:26208
  v_mfma_f32_32x32x16_bf16 v[64:79], v[100:103], v[56:59], v[64:79]
  s_setprio 1
  s_waitcnt lgkmcnt(0)
  v_mfma_f32_32x32x16_bf16 v[20:35], v[80:83], v[52:55], v[20:35]
  v_mfma_f32_16x16x32_bf16 v[104:107], v[80:83], v[116:119], v[104:107]
  ds_read_b128 v[56:59], v17 offset:0
  ds_read_b64_tr_b16 v[92:93], v9 offset:24608
  ds_read_b64_tr_b16 v[94:95], v9 offset:26144
  v_mfma_f32_32x32x16_bf16 v[36:51], v[84:87], v[52:55], v[36:51]
  ds_read_b64_tr_b16 v[96:97], v9 offset:24640
  ds_read_b64_tr_b16 v[98:99], v9 offset:26176
  ds_read_b64_tr_b16 v[100:101], v9 offset:24672
  ds_read_b64_tr_b16 v[102:103], v9 offset:26208
  v_mfma_f32_32x32x16_bf16 v[64:79], v[88:91], v[52:55], v[64:79]
  s_setprio 0
  s_waitcnt lgkmcnt(0)
  v_mfma_f32_32x32x16_bf16 v[20:35], v[92:95], v[56:59], v[20:35]
  ds_read_b128 v[52:55], v18 offset:0
  ds_read_b64_tr_b16 v[80:81], v10 offset:24608
  ds_read_b64_tr_b16 v[82:83], v10 offset:26144
  v_mfma_f32_32x32x16_bf16 v[36:51], v[96:99], v[56:59], v[36:51]
  v_mfma_f32_16x16x32_bf16 v[108:111], v[96:99], v[116:119], v[108:111]
  ds_read_b64_tr_b16 v[84:85], v10 offset:24640
  ds_read_b64_tr_b16 v[86:87], v10 offset:26176
  ds_read_b64_tr_b16 v[88:89], v10 offset:24672
  ds_read_b64_tr_b16 v[90:91], v10 offset:26208
  v_mfma_f32_32x32x16_bf16 v[64:79], v[100:103], v[56:59], v[64:79]
  s_setprio 0
  s_waitcnt lgkmcnt(0)
  v_mfma_f32_32x32x16_bf16 v[20:35], v[80:83], v[52:55], v[20:35]
  ds_read_b128 v[56:59], v19 offset:0
  ds_read_b64_tr_b16 v[92:93], v11 offset:24608
  ds_read_b64_tr_b16 v[94:95], v11 offset:26144
  v_mfma_f32_32x32x16_bf16 v[36:51], v[84:87], v[52:55], v[36:51]
  ds_read_b64_tr_b16 v[96:97], v11 offset:24640
  ds_read_b64_tr_b16 v[98:99], v11 offset:26176
  ds_read_b64_tr_b16 v[100:101], v11 offset:24672
  ds_read_b64_tr_b16 v[102:103], v11 offset:26208
  v_mfma_f32_32x32x16_bf16 v[64:79], v[88:91], v[52:55], v[64:79]
  v_mfma_f32_16x16x32_bf16 v[112:115], v[88:91], v[116:119], v[112:115]
  s_setprio 2
  s_waitcnt lgkmcnt(0)
  s_barrier
  v_mfma_f32_32x32x16_bf16 v[20:35], v[92:95], v[56:59], v[20:35]
  ds_read_b128 v[52:55], v16 offset:16384
  ds_read_b64_tr_b16 v[80:81], v8 offset:49216
  ds_read_b64_tr_b16 v[82:83], v8 offset:50752
  v_mfma_f32_32x32x16_bf16 v[36:51], v[96:99], v[56:59], v[36:51]
  ds_read_b64_tr_b16 v[84:85], v8 offset:49248
  ds_read_b64_tr_b16 v[86:87], v8 offset:50784
  ds_read_b64_tr_b16 v[88:89], v8 offset:49280
  ds_read_b64_tr_b16 v[90:91], v8 offset:50816
  v_mfma_f32_32x32x16_bf16 v[64:79], v[100:103], v[56:59], v[64:79]
  s_setprio 1
  s_waitcnt lgkmcnt(0)
  v_mfma_f32_32x32x16_bf16 v[20:35], v[80:83], v[52:55], v[20:35]
  v_mfma_f32_16x16x32_bf16 v[104:107], v[80:83], v[116:119], v[104:107]
  ds_read_b128 v[56:59], v17 offset:16384
  ds_read_b64_tr_b16 v[92:93], v9 offset:49216
  ds_read_b64_tr_b16 v[94:95], v9 offset:50752
  v_mfma_f32_32x32x16_bf16 v[36:51], v[84:87], v[52:55], v[36:51]
  ds_read_b64_tr_b16 v[96:97], v9 offset:49248
  ds_read_b64_tr_b16 v[98:99], v9 offset:50784
  ds_read_b64_tr_b16 v[100:101], v9 offset:49280
  ds_read_b64_tr_b16 v[102:103], v9 offset:50816
  v_mfma_f32_32x32x16_bf16 v[64:79], v[88:91], v[52:55], v[64:79]
  s_setprio 0
  s_waitcnt lgkmcnt(0)
  v_mfma_f32_32x32x16_bf16 v[20:35], v[92:95], v[56:59], v[20:35]
  ds_read_b128 v[52:55], v18 offset:16384
  ds_read_b64_tr_b16 v[80:81], v10 offset:49216
  ds_read_b64_tr_b16 v[82:83], v10 offset:50752
  v_mfma_f32_32x32x16_bf16 v[36:51], v[96:99], v[56:59], v[36:51]
  v_mfma_f32_16x16x32_bf16 v[108:111], v[96:99], v[116:119], v[108:111]
  ds_read_b64_tr_b16 v[84:85], v10 offset:49248
  ds_read_b64_tr_b16 v[86:87], v10 offset:50784
  ds_read_b64_tr_b16 v[88:89], v10 offset:49280
  ds_read_b64_tr_b16 v[90:91], v10 offset:50816
  v_mfma_f32_32x32x16_bf16 v[64:79], v[100:103], v[56:59], v[64:79]
  s_setprio 0
  s_waitcnt lgkmcnt(0)
  v_mfma_f32_32x32x16_bf16 v[20:35], v[80:83], v[52:55], v[20:35]
  ds_read_b128 v[56:59], v19 offset:16384
  ds_read_b64_tr_b16 v[92:93], v11 offset:49216
  ds_read_b64_tr_b16 v[94:95], v11 offset:50752
  v_mfma_f32_32x32x16_bf16 v[36:51], v[84:87], v[52:55], v[36:51]
  ds_read_b64_tr_b16 v[96:97], v11 offset:49248
  ds_read_b64_tr_b16 v[98:99], v11 offset:50784
  ds_read_b64_tr_b16 v[100:101], v11 offset:49280
  ds_read_b64_tr_b16 v[102:103], v11 offset:50816
  v_mfma_f32_32x32x16_bf16 v[64:79], v[88:91], v[52:55], v[64:79]
  v_mfma_f32_16x16x32_bf16 v[112:115], v[88:91], v[116:119], v[112:115]
  s_setprio 2
  s_waitcnt lgkmcnt(0)
  v_mfma_f32_32x32x16_bf16 v[20:35], v[92:95], v[56:59], v[20:35]
  v_mfma_f32_32x32x16_bf16 v[36:51], v[96:99], v[56:59], v[36:51]
  v_mfma_f32_32x32x16_bf16 v[64:79], v[100:103], v[56:59], v[64:79]
  s_setprio 0
  s_nop 4
  s_mov_b32 exec_lo, 0x00030003
  s_mov_b32 exec_hi, 0x00030003
  ds_write_b128 v128, v[104:107] offset:0
  ds_write_b128 v128, v[108:111] offset:128
  ds_write_b128 v128, v[112:115] offset:256
  s_mov_b64 exec, -1
  s_waitcnt lgkmcnt(0)
  s_barrier
  ds_read_b32 v8, v130 offset:0
  ds_read_b32 v9, v130 offset:384
  ds_read_b32 v10, v130 offset:768
  ds_read_b32 v11, v130 offset:1152
  ds_read_b32 v12, v130 offset:128
  ds_read_b32 v13, v130 offset:512
  ds_read_b32 v14, v130 offset:896
  ds_read_b32 v15, v130 offset:1280
  ds_read_b32 v16, v130 offset:256
  ds_read_b32 v17, v130 offset:640
  ds_read_b32 v18, v130 offset:1024
  ds_read_b32 v19, v130 offset:1408
  s_waitcnt lgkmcnt(8)
  v_add_f32 v8, v8, v9
  v_add_f32 v10, v10, v11
  v_add_f32 v8, v8, v10
  ds_write_b32 v129, v8 offset:0
  s_waitcnt lgkmcnt(5)
  v_add_f32 v12, v12, v13
  v_add_f32 v14, v14, v15
  v_add_f32 v12, v12, v14
  ds_write_b32 v129, v12 offset:128
  s_waitcnt lgkmcnt(2)
  v_add_f32 v16, v16, v17
  v_add_f32 v18, v18, v19
  v_add_f32 v16, v16, v18
  ds_write_b32 v129, v16 offset:256
  s_waitcnt lgkmcnt(0)
  ds_read_b128 v[80:83], v131 offset:0
  ds_read_b128 v[84:87], v131 offset:32
  ds_read_b128 v[88:91], v131 offset:64
  ds_read_b128 v[92:95], v131 offset:96
  ds_read_b128 v[140:143], v131 offset:128
  ds_read_b128 v[144:147], v131 offset:160
  ds_read_b128 v[148:151], v131 offset:192
  ds_read_b128 v[152:155], v131 offset:224
  s_waitcnt lgkmcnt(4)
  v_pk_fma_f32 v[8:9], v[132:133], v[80:81], v[20:21] op_sel_hi:[0,1,1]
  v_pk_fma_f32 v[10:11], v[132:133], v[82:83], v[22:23] op_sel_hi:[0,1,1]
  v_pk_fma_f32 v[12:13], v[132:133], v[84:85], v[24:25] op_sel_hi:[0,1,1]
  v_pk_fma_f32 v[14:15], v[132:133], v[86:87], v[26:27] op_sel_hi:[0,1,1]
  v_pk_fma_f32 v[52:53], v[132:133], v[88:89], v[28:29] op_sel_hi:[0,1,1]
  v_pk_fma_f32 v[54:55], v[132:133], v[90:91], v[30:31] op_sel_hi:[0,1,1]
  v_pk_fma_f32 v[56:57], v[132:133], v[92:93], v[32:33] op_sel_hi:[0,1,1]
  v_pk_fma_f32 v[58:59], v[132:133], v[94:95], v[34:35] op_sel_hi:[0,1,1]
  ds_read_b128 v[80:83], v131 offset:256
  ds_read_b128 v[84:87], v131 offset:288
  ds_read_b128 v[88:91], v131 offset:320
  ds_read_b128 v[92:95], v131 offset:352
  v_pk_mul_f32 v[96:97], v[134:135], v[8:9] op_sel_hi:[0,1]
  v_pk_mul_f32 v[98:99], v[134:135], v[10:11] op_sel_hi:[0,1]
  v_pk_mul_f32 v[100:101], v[134:135], v[12:13] op_sel_hi:[0,1]
  v_pk_mul_f32 v[102:103], v[134:135], v[14:15] op_sel_hi:[0,1]
  v_exp_f32 v96, v96
  v_exp_f32 v97, v97
  v_exp_f32 v98, v98
  v_exp_f32 v99, v99
  v_exp_f32 v100, v100
  v_exp_f32 v101, v101
  v_exp_f32 v102, v102
  v_exp_f32 v103, v103
  v_pk_mul_f32 v[8:9], v[8:9], v[52:53]
  v_pk_mul_f32 v[10:11], v[10:11], v[54:55]
  v_pk_mul_f32 v[12:13], v[12:13], v[56:57]
  v_pk_mul_f32 v[14:15], v[14:15], v[58:59]
  v_pk_fma_f32 v[96:97], v[96:97], v[136:137], v[136:137] op_sel_hi:[1,0,0]
  v_pk_fma_f32 v[98:99], v[98:99], v[136:137], v[136:137] op_sel_hi:[1,0,0]
  v_pk_fma_f32 v[100:101], v[100:101], v[136:137], v[136:137] op_sel_hi:[1,0,0]
  v_pk_fma_f32 v[102:103], v[102:103], v[136:137], v[136:137] op_sel_hi:[1,0,0]
  v_rcp_f32 v96, v96
  v_rcp_f32 v97, v97
  v_rcp_f32 v98, v98
  v_rcp_f32 v99, v99
  v_rcp_f32 v100, v100
  v_rcp_f32 v101, v101
  v_rcp_f32 v102, v102
  v_rcp_f32 v103, v103
  v_pk_mul_f32 v[8:9], v[8:9], v[96:97]
  v_pk_mul_f32 v[10:11], v[10:11], v[98:99]
  v_pk_mul_f32 v[12:13], v[12:13], v[100:101]
  v_pk_mul_f32 v[14:15], v[14:15], v[102:103]
  v_cvt_pk_bf16_f32 v16, v8, v9
  v_cvt_pk_bf16_f32 v17, v10, v11
  v_cvt_pk_bf16_f32 v18, v12, v13
  v_cvt_pk_bf16_f32 v19, v14, v15
  s_add_u32 s44, s60, 0
  s_cmp_ge_u32 s44, s65
  s_cbranch_scc1 L_act_skip_28
  s_add_u32 s44, s63, 0
  s_cmp_eq_u32 s39, 0
  s_cbranch_scc1 L_st_slow_29
  buffer_store_dwordx4 v[16:19], v2, s[28:31], s44 offen
  s_branch L_st_done_30
L_st_slow_29:
  buffer_store_dwordx4 v[16:19], v2, s[28:31], s44 offen sc1
L_st_done_30:
L_act_skip_28:
  s_nop 1
  s_waitcnt lgkmcnt(4)
  v_pk_fma_f32 v[8:9], v[132:133], v[140:141], v[36:37] op_sel_hi:[0,1,1]
  v_pk_fma_f32 v[10:11], v[132:133], v[142:143], v[38:39] op_sel_hi:[0,1,1]
  v_pk_fma_f32 v[12:13], v[132:133], v[144:145], v[40:41] op_sel_hi:[0,1,1]
  v_pk_fma_f32 v[14:15], v[132:133], v[146:147], v[42:43] op_sel_hi:[0,1,1]
  v_pk_fma_f32 v[52:53], v[132:133], v[148:149], v[44:45] op_sel_hi:[0,1,1]
  v_pk_fma_f32 v[54:55], v[132:133], v[150:151], v[46:47] op_sel_hi:[0,1,1]
  v_pk_fma_f32 v[56:57], v[132:133], v[152:153], v[48:49] op_sel_hi:[0,1,1]
  v_pk_fma_f32 v[58:59], v[132:133], v[154:155], v[50:51] op_sel_hi:[0,1,1]
  v_pk_mul_f32 v[96:97], v[134:135], v[8:9] op_sel_hi:[0,1]
  v_pk_mul_f32 v[98:99], v[134:135], v[10:11] op_sel_hi:[0,1]
  v_pk_mul_f32 v[100:101], v[134:135], v[12:13] op_sel_hi:[0,1]
  v_pk_mul_f32 v[102:103], v[134:135], v[14:15] op_sel_hi:[0,1]
  v_exp_f32 v96, v96
  v_exp_f32 v97, v97
  v_exp_f32 v98, v98
  v_exp_f32 v99, v99
  v_exp_f32 v100, v100
  v_exp_f32 v101, v101
  v_exp_f32 v102, v102
  v_exp_f32 v103, v103
  v_pk_mul_f32 v[8:9], v[8:9], v[52:53]
  v_pk_mul_f32 v[10:11], v[10:11], v[54:55]
  v_pk_mul_f32 v[12:13], v[12:13], v[56:57]
  v_pk_mul_f32 v[14:15], v[14:15], v[58:59]
  v_pk_fma_f32 v[96:97], v[96:97], v[136:137], v[136:137] op_sel_hi:[1,0,0]
  v_pk_fma_f32 v[98:99], v[98:99], v[136:137], v[136:137] op_sel_hi:[1,0,0]
  v_pk_fma_f32 v[100:101], v[100:101], v[136:137], v[136:137] op_sel_hi:[1,0,0]
  v_pk_fma_f32 v[102:103], v[102:103], v[136:137], v[136:137] op_sel_hi:[1,0,0]
  v_rcp_f32 v96, v96
  v_rcp_f32 v97, v97
  v_rcp_f32 v98, v98
  v_rcp_f32 v99, v99
  v_rcp_f32 v100, v100
  v_rcp_f32 v101, v101
  v_rcp_f32 v102, v102
  v_rcp_f32 v103, v103
  v_pk_mul_f32 v[8:9], v[8:9], v[96:97]
  v_pk_mul_f32 v[10:11], v[10:11], v[98:99]
  v_pk_mul_f32 v[12:13], v[12:13], v[100:101]
  v_pk_mul_f32 v[14:15], v[14:15], v[102:103]
  v_cvt_pk_bf16_f32 v16, v8, v9
  v_cvt_pk_bf16_f32 v17, v10, v11
  v_cvt_pk_bf16_f32 v18, v12, v13
  v_cvt_pk_bf16_f32 v19, v14, v15
  s_add_u32 s44, s60, 1
  s_cmp_ge_u32 s44, s65
  s_cbranch_scc1 L_act_skip_31
  s_add_u32 s44, s63, 1024
  s_cmp_eq_u32 s39, 0
  s_cbranch_scc1 L_st_slow_32
  buffer_store_dwordx4 v[16:19], v2, s[28:31], s44 offen
  s_branch L_st_done_33
L_st_slow_32:
  buffer_store_dwordx4 v[16:19], v2, s[28:31], s44 offen sc1
L_st_done_33:
L_act_skip_31:
  s_nop 1
  s_waitcnt lgkmcnt(0)
  v_pk_fma_f32 v[8:9], v[132:133], v[80:81], v[64:65] op_sel_hi:[0,1,1]
  v_pk_fma_f32 v[10:11], v[132:133], v[82:83], v[66:67] op_sel_hi:[0,1,1]
  v_pk_fma_f32 v[12:13], v[132:133], v[84:85], v[68:69] op_sel_hi:[0,1,1]
  v_pk_fma_f32 v[14:15], v[132:133], v[86:87], v[70:71] op_sel_hi:[0,1,1]
  v_pk_fma_f32 v[52:53], v[132:133], v[88:89], v[72:73] op_sel_hi:[0,1,1]
  v_pk_fma_f32 v[54:55], v[132:133], v[90:91], v[74:75] op_sel_hi:[0,1,1]
  v_pk_fma_f32 v[56:57], v[132:133], v[92:93], v[76:77] op_sel_hi:[0,1,1]
  v_pk_fma_f32 v[58:59], v[132:133], v[94:95], v[78:79] op_sel_hi:[0,1,1]
  v_pk_mul_f32 v[96:97], v[134:135], v[8:9] op_sel_hi:[0,1]
  v_pk_mul_f32 v[98:99], v[134:135], v[10:11] op_sel_hi:[0,1]
  v_pk_mul_f32 v[100:101], v[134:135], v[12:13] op_sel_hi:[0,1]
  v_pk_mul_f32 v[102:103], v[134:135], v[14:15] op_sel_hi:[0,1]
  v_exp_f32 v96, v96
  v_exp_f32 v97, v97
  v_exp_f32 v98, v98
  v_exp_f32 v99, v99
  v_exp_f32 v100, v100
  v_exp_f32 v101, v101
  v_exp_f32 v102, v102
  v_exp_f32 v103, v103
  v_pk_mul_f32 v[8:9], v[8:9], v[52:53]
  v_pk_mul_f32 v[10:11], v[10:11], v[54:55]
  v_pk_mul_f32 v[12:13], v[12:13], v[56:57]
  v_pk_mul_f32 v[14:15], v[14:15], v[58:59]
  v_pk_fma_f32 v[96:97], v[96:97], v[136:137], v[136:137] op_sel_hi:[1,0,0]
  v_pk_fma_f32 v[98:99], v[98:99], v[136:137], v[136:137] op_sel_hi:[1,0,0]
  v_pk_fma_f32 v[100:101], v[100:101], v[136:137], v[136:137] op_sel_hi:[1,0,0]
  v_pk_fma_f32 v[102:103], v[102:103], v[136:137], v[136:137] op_sel_hi:[1,0,0]
  v_rcp_f32 v96, v96
  v_rcp_f32 v97, v97
  v_rcp_f32 v98, v98
  v_rcp_f32 v99, v99
  v_rcp_f32 v100, v100
  v_rcp_f32 v101, v101
  v_rcp_f32 v102, v102
  v_rcp_f32 v103, v103
  v_pk_mul_f32 v[8:9], v[8:9], v[96:97]
  v_pk_mul_f32 v[10:11], v[10:11], v[98:99]
  v_pk_mul_f32 v[12:13], v[12:13], v[100:101]
  v_pk_mul_f32 v[14:15], v[14:15], v[102:103]
  v_cvt_pk_bf16_f32 v16, v8, v9
  v_cvt_pk_bf16_f32 v17, v10, v11
  v_cvt_pk_bf16_f32 v18, v12, v13
  v_cvt_pk_bf16_f32 v19, v14, v15
  s_add_u32 s44, s60, 2
  s_cmp_ge_u32 s44, s65
  s_cbranch_scc1 L_act_skip_34
  s_add_u32 s44, s63, 2048
  s_cmp_eq_u32 s39, 0
  s_cbranch_scc1 L_st_slow_35
  buffer_store_dwordx4 v[16:19], v2, s[28:31], s44 offen
  s_branch L_st_done_36
L_st_slow_35:
  buffer_store_dwordx4 v[16:19], v2, s[28:31], s44 offen sc1
L_st_done_36:
L_act_skip_34:
  s_nop 1
  s_waitcnt vmcnt(0)
  s_barrier
  s_lshr_b32 s44, s36, 2
  s_lshl_b32 s44, s44, 13
  s_and_b32 s45, s36, 1
  s_lshl_b32 s45, s45, 12
  s_add_u32 s45, s45, s44
  s_add_u32 s45, s45, 98304
  v_add_u32 v5, s45, v2
  v_add_u32 v6, s44, v4
  v_add_u32 v8, 65536, v6
  s_lshl_b32 s45, s36, 11
  s_add_u32 s45, s45, 0
  s_xor_b32 s46, s36, 4
  s_lshl_b32 s44, s46, 11
  s_add_u32 s44, s44, 0
  v_add_u32 v9, s45, v2
  v_add_u32 v10, s44, v2
  s_barrier
  s_barrier
  ds_read_b128 v[28:31], v5 offset:0
  ds_read_b64_tr_b16 v[40:41], v6 offset:0
  ds_read_b64_tr_b16 v[42:43], v6 offset:1024
  ds_read_b128 v[32:35], v5 offset:1024
  ds_read_b64_tr_b16 v[44:45], v6 offset:2048
  ds_read_b64_tr_b16 v[46:47], v6 offset:3072
  s_waitcnt lgkmcnt(3)
  v_mfma_f32_32x32x16_bf16 v[12:27], v[40:43], v[28:31], 0
  ds_read_b128 v[36:39], v5 offset:2048
  ds_read_b64_tr_b16 v[48:49], v6 offset:4096
  ds_read_b64_tr_b16 v[50:51], v6 offset:5120
  s_waitcnt lgkmcnt(3)
  v_mfma_f32_32x32x16_bf16 v[12:27], v[44:47], v[32:35], v[12:27]
  ds_read_b128 v[28:31], v5 offset:3072
  ds_read_b64_tr_b16 v[40:41], v6 offset:6144
  ds_read_b64_tr_b16 v[42:43], v6 offset:7168
  s_waitcnt lgkmcnt(0)
  s_barrier
  v_mfma_f32_32x32x16_bf16 v[12:27], v[48:51], v[36:39], v[12:27]
  ds_read_b128 v[32:35], v5 offset:16384
  ds_read_b64_tr_b16 v[44:45], v6 offset:16384
  ds_read_b64_tr_b16 v[46:47], v6 offset:17408
  v_mfma_f32_32x32x16_bf16 v[12:27], v[40:43], v[28:31], v[12:27]
  ds_read_b128 v[36:39], v5 offset:17408
  ds_read_b64_tr_b16 v[48:49], v6 offset:18432
  ds_read_b64_tr_b16 v[50:51], v6 offset:19456
  s_waitcnt lgkmcnt(3)
  v_mfma_f32_32x32x16_bf16 v[12:27], v[44:47], v[32:35], v[12:27]
  ds_read_b128 v[28:31], v5 offset:18432
  ds_read_b64_tr_b16 v[40:41], v6 offset:20480
  ds_read_b64_tr_b16 v[42:43], v6 offset:21504
  s_waitcnt lgkmcnt(3)
  v_mfma_f32_32x32x16_bf16 v[12:27], v[48:51], v[36:39], v[12:27]
  ds_read_b128 v[32:35], v5 offset:19456
  ds_read_b64_tr_b16 v[44:45], v6 offset:22528
  ds_read_b64_tr_b16 v[46:47], v6 offset:23552
  s_waitcnt lgkmcnt(0)
  s_barrier
  v_mfma_f32_32x32x16_bf16 v[12:27], v[40:43], v[28:31], v[12:27]
  ds_read_b128 v[36:39], v5 offset:32768
  ds_read_b64_tr_b16 v[48:49], v6 offset:32768
  ds_read_b64_tr_b16 v[50:51], v6 offset:33792
  v_mfma_f32_32x32x16_bf16 v[12:27], v[44:47], v[32:35], v[12:27]
  ds_read_b128 v[28:31], v5 offset:33792
  ds_read_b64_tr_b16 v[40:41], v6 offset:34816
  ds_read_b64_tr_b16 v[42:43], v6 offset:35840
  s_waitcnt lgkmcnt(3)
  v_mfma_f32_32x32x16_bf16 v[12:27], v[48:51], v[36:39], v[12:27]
  ds_read_b128 v[32:35], v5 offset:34816
  ds_read_b64_tr_b16 v[44:45], v6 offset:36864
  ds_read_b64_tr_b16 v[46:47], v6 offset:37888
  s_waitcnt lgkmcnt(3)
  v_mfma_f32_32x32x16_bf16 v[12:27], v[40:43], v[28:31], v[12:27]
  ds_read_b128 v[36:39], v5 offset:35840
  ds_read_b64_tr_b16 v[48:49], v6 offset:38912
  ds_read_b64_tr_b16 v[50:51], v6 offset:39936
  s_waitcnt lgkmcnt(0)
  s_barrier
  v_mfma_f32_32x32x16_bf16 v[12:27], v[44:47], v[32:35], v[12:27]
  ds_read_b128 v[28:31], v5 offset:0
  ds_read_b64_tr_b16 v[40:41], v6 offset:49152
  ds_read_b64_tr_b16 v[42:43], v6 offset:50176
  v_mfma_f32_32x32x16_bf16 v[12:27], v[48:51], v[36:39], v[12:27]
  ds_read_b128 v[32:35], v5 offset:1024
  ds_read_b64_tr_b16 v[44:45], v6 offset:51200
  ds_read_b64_tr_b16 v[46:47], v6 offset:52224
  s_waitcnt lgkmcnt(3)
  v_mfma_f32_32x32x16_bf16 v[12:27], v[40:43], v[28:31], v[12:27]
  ds_read_b128 v[36:39], v5 offset:2048
  ds_read_b64_tr_b16 v[48:49], v6 offset:53248
  ds_read_b64_tr_b16 v[50:51], v6 offset:54272
  s_waitcnt lgkmcnt(3)
  v_mfma_f32_32x32x16_bf16 v[12:27], v[44:47], v[32:35], v[12:27]
  ds_read_b128 v[28:31], v5 offset:3072
  ds_read_b64_tr_b16 v[40:41], v6 offset:55296
  ds_read_b64_tr_b16 v[42:43], v6 offset:56320
  s_waitcnt lgkmcnt(0)
  s_barrier
  v_mfma_f32_32x32x16_bf16 v[12:27], v[48:51], v[36:39], v[12:27]
  ds_read_b128 v[32:35], v5 offset:16384
  ds_read_b64_tr_b16 v[44:45], v8 offset:0
  ds_read_b64_tr_b16 v[46:47], v8 offset:1024
  v_mfma_f32_32x32x16_bf16 v[12:27], v[40:43], v[28:31], v[12:27]
  ds_read_b128 v[36:39], v5 offset:17408
  ds_read_b64_tr_b16 v[48:49], v8 offset:2048
  ds_read_b64_tr_b16 v[50:51], v8 offset:3072
  s_waitcnt lgkmcnt(3)
  v_mfma_f32_32x32x16_bf16 v[12:27], v[44:47], v[32:35], v[12:27]
  ds_read_b128 v[28:31], v5 offset:18432
  ds_read_b64_tr_b16 v[40:41], v8 offset:4096
  ds_read_b64_tr_b16 v[42:43], v8 offset:5120
  s_waitcnt lgkmcnt(3)
  v_mfma_f32_32x32x16_bf16 v[12:27], v[48:51], v[36:39], v[12:27]
  ds_read_b128 v[32:35], v5 offset:19456
  ds_read_b64_tr_b16 v[44:45], v8 offset:6144
  ds_read_b64_tr_b16 v[46:47], v8 offset:7168
  s_waitcnt lgkmcnt(0)
  s_barrier
  v_mfma_f32_32x32x16_bf16 v[12:27], v[40:43], v[28:31], v[12:27]
  ds_read_b128 v[36:39], v5 offset:32768
  ds_read_b64_tr_b16 v[48:49], v8 offset:16384
  ds_read_b64_tr_b16 v[50:51], v8 offset:17408
  v_mfma_f32_32x32x16_bf16 v[12:27], v[44:47], v[32:35], v[12:27]
  ds_read_b128 v[28:31], v5 offset:33792
  ds_read_b64_tr_b16 v[40:41], v8 offset:18432
  ds_read_b64_tr_b16 v[42:43], v8 offset:19456
  s_waitcnt lgkmcnt(3)
  v_mfma_f32_32x32x16_bf16 v[12:27], v[48:51], v[36:39], v[12:27]
  ds_read_b128 v[32:35], v5 offset:34816
  ds_read_b64_tr_b16 v[44:45], v8 offset:20480
  ds_read_b64_tr_b16 v[46:47], v8 offset:21504
  s_waitcnt lgkmcnt(3)
  v_mfma_f32_32x32x16_bf16 v[12:27], v[40:43], v[28:31], v[12:27]
  ds_read_b128 v[36:39], v5 offset:35840
  ds_read_b64_tr_b16 v[48:49], v8 offset:22528
  ds_read_b64_tr_b16 v[50:51], v8 offset:23552
  s_waitcnt lgkmcnt(0)
  s_barrier
  v_mfma_f32_32x32x16_bf16 v[12:27], v[44:47], v[32:35], v[12:27]
  ds_read_b128 v[28:31], v5 offset:0
  ds_read_b64_tr_b16 v[40:41], v6 offset:0
  ds_read_b64_tr_b16 v[42:43], v6 offset:1024
  v_mfma_f32_32x32x16_bf16 v[12:27], v[48:51], v[36:39], v[12:27]
  ds_read_b128 v[32:35], v5 offset:1024
  ds_read_b64_tr_b16 v[44:45], v6 offset:2048
  ds_read_b64_tr_b16 v[46:47], v6 offset:3072
  s_waitcnt lgkmcnt(3)
  v_mfma_f32_32x32x16_bf16 v[12:27], v[40:43], v[28:31], v[12:27]
  ds_read_b128 v[36:39], v5 offset:2048
  ds_read_b64_tr_b16 v[48:49], v6 offset:4096
  ds_read_b64_tr_b16 v[50:51], v6 offset:5120
  s_waitcnt lgkmcnt(3)
  v_mfma_f32_32x32x16_bf16 v[12:27], v[44:47], v[32:35], v[12:27]
  ds_read_b128 v[28:31], v5 offset:3072
  ds_read_b64_tr_b16 v[40:41], v6 offset:6144
  ds_read_b64_tr_b16 v[42:43], v6 offset:7168
  s_waitcnt lgkmcnt(0)
  s_barrier
  v_mfma_f32_32x32x16_bf16 v[12:27], v[48:51], v[36:39], v[12:27]
  ds_read_b128 v[32:35], v5 offset:16384
  ds_read_b64_tr_b16 v[44:45], v6 offset:16384
  ds_read_b64_tr_b16 v[46:47], v6 offset:17408
  v_mfma_f32_32x32x16_bf16 v[12:27], v[40:43], v[28:31], v[12:27]
  ds_read_b128 v[36:39], v5 offset:17408
  ds_read_b64_tr_b16 v[48:49], v6 offset:18432
  ds_read_b64_tr_b16 v[50:51], v6 offset:19456
  s_waitcnt lgkmcnt(3)
  v_mfma_f32_32x32x16_bf16 v[12:27], v[44:47], v[32:35], v[12:27]
  ds_read_b128 v[28:31], v5 offset:18432
  ds_read_b64_tr_b16 v[40:41], v6 offset:20480
  ds_read_b64_tr_b16 v[42:43], v6 offset:21504
  s_waitcnt lgkmcnt(3)
  v_mfma_f32_32x32x16_bf16 v[12:27], v[48:51], v[36:39], v[12:27]
  ds_read_b128 v[32:35], v5 offset:19456
  ds_read_b64_tr_b16 v[44:45], v6 offset:22528
  ds_read_b64_tr_b16 v[46:47], v6 offset:23552
  s_waitcnt lgkmcnt(0)
  s_barrier
  v_mfma_f32_32x32x16_bf16 v[12:27], v[40:43], v[28:31], v[12:27]
  ds_read_b128 v[36:39], v5 offset:32768
  ds_read_b64_tr_b16 v[48:49], v6 offset:32768
  ds_read_b64_tr_b16 v[50:51], v6 offset:33792
  v_mfma_f32_32x32x16_bf16 v[12:27], v[44:47], v[32:35], v[12:27]
  ds_read_b128 v[28:31], v5 offset:33792
  ds_read_b64_tr_b16 v[40:41], v6 offset:34816
  ds_read_b64_tr_b16 v[42:43], v6 offset:35840
  s_waitcnt lgkmcnt(3)
  v_mfma_f32_32x32x16_bf16 v[12:27], v[48:51], v[36:39], v[12:27]
  ds_read_b128 v[32:35], v5 offset:34816
  ds_read_b64_tr_b16 v[44:45], v6 offset:36864
  ds_read_b64_tr_b16 v[46:47], v6 offset:37888
  s_waitcnt lgkmcnt(3)
  v_mfma_f32_32x32x16_bf16 v[12:27], v[40:43], v[28:31], v[12:27]
  ds_read_b128 v[36:39], v5 offset:35840
  ds_read_b64_tr_b16 v[48:49], v6 offset:38912
  ds_read_b64_tr_b16 v[50:51], v6 offset:39936
  s_waitcnt lgkmcnt(0)
  s_barrier
  v_mfma_f32_32x32x16_bf16 v[12:27], v[44:47], v[32:35], v[12:27]
  ds_read_b128 v[28:31], v5 offset:0
  ds_read_b64_tr_b16 v[40:41], v6 offset:49152
  ds_read_b64_tr_b16 v[42:43], v6 offset:50176
  v_mfma_f32_32x32x16_bf16 v[12:27], v[48:51], v[36:39], v[12:27]
  ds_read_b128 v[32:35], v5 offset:1024
  ds_read_b64_tr_b16 v[44:45], v6 offset:51200
  ds_read_b64_tr_b16 v[46:47], v6 offset:52224
  s_waitcnt lgkmcnt(3)
  v_mfma_f32_32x32x16_bf16 v[12:27], v[40:43], v[28:31], v[12:27]
  ds_read_b128 v[36:39], v5 offset:2048
  ds_read_b64_tr_b16 v[48:49], v6 offset:53248
  ds_read_b64_tr_b16 v[50:51], v6 offset:54272
  s_waitcnt lgkmcnt(3)
  v_mfma_f32_32x32x16_bf16 v[12:27], v[44:47], v[32:35], v[12:27]
  ds_read_b128 v[28:31], v5 offset:3072
  ds_read_b64_tr_b16 v[40:41], v6 offset:55296
  ds_read_b64_tr_b16 v[42:43], v6 offset:56320
  s_waitcnt lgkmcnt(0)
  s_barrier
  v_mfma_f32_32x32x16_bf16 v[12:27], v[48:51], v[36:39], v[12:27]
  ds_read_b128 v[32:35], v5 offset:16384
  ds_read_b64_tr_b16 v[44:45], v8 offset:0
  ds_read_b64_tr_b16 v[46:47], v8 offset:1024
  v_mfma_f32_32x32x16_bf16 v[12:27], v[40:43], v[28:31], v[12:27]
  ds_read_b128 v[36:39], v5 offset:17408
  ds_read_b64_tr_b16 v[48:49], v8 offset:2048
  ds_read_b64_tr_b16 v[50:51], v8 offset:3072
  s_waitcnt lgkmcnt(3)
  v_mfma_f32_32x32x16_bf16 v[12:27], v[44:47], v[32:35], v[12:27]
  ds_read_b128 v[28:31], v5 offset:18432
  ds_read_b64_tr_b16 v[40:41], v8 offset:4096
  ds_read_b64_tr_b16 v[42:43], v8 offset:5120
  s_waitcnt lgkmcnt(3)
  v_mfma_f32_32x32x16_bf16 v[12:27], v[48:51], v[36:39], v[12:27]
  s_waitcnt lgkmcnt(0)
  v_mfma_f32_32x32x16_bf16 v[12:27], v[40:43], v[28:31], v[12:27]
  s_nop 11
  ds_write_b128 v9, v[20:23]
  ds_write_b128 v9, v[24:27] offset:1024
  s_waitcnt lgkmcnt(0)
  s_barrier
  ds_read_b128 v[52:55], v10
  ds_read_b128 v[56:59], v10 offset:1024
  s_waitcnt lgkmcnt(0)
  v_add_f32 v12, v12, v52
  v_add_f32 v13, v13, v53
  v_add_f32 v14, v14, v54
  v_add_f32 v15, v15, v55
  v_add_f32 v16, v16, v56
  v_add_f32 v17, v17, v57
  v_add_f32 v18, v18, v58
  v_add_f32 v19, v19, v59
  v_lshlrev_b32 v11, 16, v60
  v_add_f32 v12, v12, v11
  v_and_b32 v11, 0xffff0000, v60
  v_add_f32 v13, v13, v11
  v_lshlrev_b32 v11, 16, v61
  v_add_f32 v14, v14, v11
  v_and_b32 v11, 0xffff0000, v61
  v_add_f32 v15, v15, v11
  v_lshlrev_b32 v11, 16, v62
  v_add_f32 v16, v16, v11
  v_and_b32 v11, 0xffff0000, v62
  v_add_f32 v17, v17, v11
  v_lshlrev_b32 v11, 16, v63
  v_add_f32 v18, v18, v11
  v_and_b32 v11, 0xffff0000, v63
  v_add_f32 v19, v19, v11
  v_cvt_pk_bf16_f32 v52, v12, v13
  v_cvt_pk_bf16_f32 v53, v14, v15
  v_cvt_pk_bf16_f32 v54, v16, v17
  v_cvt_pk_bf16_f32 v55, v18, v19
  s_nop 1
  v_permlane32_swap_b32 v52, v54
  v_permlane32_swap_b32 v53, v55
  buffer_store_dwordx4 v[52:55], v7, s[24:27], s72 offen
  s_waitcnt vmcnt(0)
  s_endpgm
L_end:
  s_endpgm
.section .rodata,"a"
.p2align 6
.amdhsa_kernel sequential_preLN__softmax_full_mha__swiglu_ffn__prompt_kernel
  .amdhsa_next_free_vgpr 168
  .amdhsa_next_free_sgpr 102
  .amdhsa_accum_offset 168
  .amdhsa_group_segment_fixed_size 0
  .amdhsa_kernarg_size 80
  .amdhsa_user_sgpr_count 2
  .amdhsa_user_sgpr_kernarg_segment_ptr 1
  .amdhsa_system_sgpr_workgroup_id_x 1
.end_amdhsa_kernel
```
